```python
import torch

def _softmax(x, axis=-1):
    return torch.softmax(x, dim=axis)
def _gelu(x):
    return torch.nn.functional.gelu(x, approximate="tanh")
def _silu(x):
    return torch.nn.functional.silu(x)
def _sigmoid(x):
    return torch.sigmoid(x)
def _layernorm(x, axis=-1, eps=1e-5):
    m = x.mean(dim=axis, keepdim=True)
    v = x.var(dim=axis, keepdim=True, unbiased=False)
    return (x - m) / torch.sqrt(v + eps)
def _scatter_add(tgt, idx, src, axis=0):
    return tgt.clone().index_add_(axis, idx, src)
def _segment_sum(src, seg, n):
    out = torch.zeros((n,) + src.shape[1:], dtype=src.dtype)
    return out.index_add_(0, seg, src)
def _pad(x, pw):
    flat = tuple(v for pair in reversed(pw) for v in pair)
    return torch.nn.functional.pad(x, flat)

kernel_name = 'gated_mix__gqa_block_cached__glu_gated_glu__decode'

def setup_inputs():

    _w = (lambda a: (lambda t: t.to(torch.bfloat16) if t.is_floating_point() else t)(torch.as_tensor(a)))
    def _A_setup():
        B, Sq, D = 4, 1, 512
        Hq, Hkv, Sk, Dh = 32, 8, 8192, 128
        assert Hq % Hkv == 0, (Hq, Hkv)
        return {
            "x": _w((lambda *s: torch.randn(*s, dtype=torch.bfloat16) * 0.05)(B, Sq, D)),
            "k_cache": _w((lambda *s: torch.randn(*s, dtype=torch.bfloat16) * 6.4)(B, Hkv, Sk, Dh)),
            "v_cache": _w((lambda *s: torch.randn(*s, dtype=torch.bfloat16) * 3.2)(B, Hkv, Sk, Dh)),
            "wq": _w((lambda *s: torch.randn(*s, dtype=torch.bfloat16) * 6.4)(D, Hq * Dh) * (D ** -0.5)),
            "wo": _w((lambda *s: torch.randn(*s, dtype=torch.bfloat16) * 3.2)(Hq * Dh, D) * ((Hq * Dh) ** -0.5)),
        }
    _A_in = _A_setup()

    def _B_setup():
        B, S, D, F = 4, 1, 512, 1792
        return {
            "x": _w((lambda *s: torch.randn(*s, dtype=torch.bfloat16) * 0.05)(B, S, D)),
            "w_gate": _w((lambda *s: torch.randn(*s, dtype=torch.bfloat16) * 3.2)(D, F)),
            "w_up": _w((lambda *s: torch.randn(*s, dtype=torch.bfloat16) * 0.2)(D, F)),
            "w_down": _w((lambda *s: torch.randn(*s, dtype=torch.bfloat16) * 0.2)(F, D)),
        }
    _B_in = _B_setup()

    return {
        "A_x": _A_in["x"],
        "A_k_cache": _A_in["k_cache"],
        "A_v_cache": _A_in["v_cache"],
        "A_wq": _A_in["wq"],
        "A_wo": _A_in["wo"],
        "B_x": _B_in["x"],
        "B_w_gate": _B_in["w_gate"],
        "B_w_up": _B_in["w_up"],
        "B_w_down": _B_in["w_down"],
        "gate_w": _w((lambda *s: torch.randn(*s, dtype=torch.bfloat16) * 0.05)(512) * 16.0),
    }

def reference(A_x, A_k_cache, A_v_cache, A_wq, A_wo, B_x, B_w_gate, B_w_up, B_w_down, gate_w):
    def _A_ref(x, k_cache, v_cache, wq, wo):
        B, Sq, D = x.shape
        Hq, Dh = 32, 128
        Hkv = k_cache.shape[1]
        rep = Hq // Hkv
        q = (lambda x, *d: x.permute(*d))((x @ wq).reshape(B, Sq, Hq, Dh), 0, 2, 1, 3)
        k = (lambda x, n, axis: torch.repeat_interleave(x, n, dim=axis))(k_cache, rep, axis=1)
        v = (lambda x, n, axis: torch.repeat_interleave(x, n, dim=axis))(v_cache, rep, axis=1)
        scores = torch.einsum("bhqd,bhkd->bhqk", q, k) * (Dh ** -0.5)
        p = _softmax(scores, axis=-1)
        o = torch.einsum("bhqk,bhkd->bhqd", p, v)
        return (lambda x, *d: x.permute(*d))(o, 0, 2, 1, 3).reshape(B, Sq, Hq * Dh) @ wo

    def _B_ref(x, w_gate, w_up, w_down):
        g = torch.einsum("bsd,df->bsf", x, w_gate)
        u = torch.einsum("bsd,df->bsf", x, w_up)
        h = _sigmoid(g) * u
        return torch.einsum("bsf,fd->bsd", h, w_down)

    x = A_x
    g = _sigmoid((x * gate_w).sum(-1, keepdims=True))
    a = _A_ref(x, A_k_cache, A_v_cache, A_wq, A_wo)
    b = _B_ref(x, B_w_gate, B_w_up, B_w_down)
    return g * a + (1 - g) * b
```

```asm
; @launch kernel=gated_mix__gqa_block_cached__glu_gated_glu__decode_f_kernel grid=(256,1,1) block=(512,1,1) lds=132096
; @launch kernel=gated_mix__gqa_block_cached__glu_gated_glu__decode_k3_kernel grid=(368,1,1) block=(512,1,1) lds=17408
.amdgcn_target "amdgcn-amd-amdhsa--gfx950"
.text
.globl gated_mix__gqa_block_cached__glu_gated_glu__decode_f_kernel
.p2align 8
.type gated_mix__gqa_block_cached__glu_gated_glu__decode_f_kernel,@function
gated_mix__gqa_block_cached__glu_gated_glu__decode_f_kernel:
  s_cmp_ge_u32 s2, 256
  s_cbranch_scc1 F_END
  s_load_dwordx4 s[4:7], s[0:1], 8
  s_load_dwordx4 s[8:11], s[0:1], 88
  s_load_dwordx2 s[50:51], s[0:1], 0
  s_load_dwordx2 s[52:53], s[0:1], 24
  s_load_dwordx4 s[56:59], s[0:1], 48
  v_lshrrev_b32 v1, 6, v0
  v_and_b32 v2, 63, v0
  v_readfirstlane_b32 s20, v1
  v_lshrrev_b32 v3, 4, v2
  v_and_b32 v4, 15, v2
  s_lshr_b32 s32, s2, 6
  s_lshr_b32 s33, s2, 3
  s_xor_b32 s86, s2, s33
  s_and_b32 s86, s86, 7
  s_and_b32 s33, s33, 7
  s_lshl_b32 s23, s20, 14
  s_waitcnt lgkmcnt(0)
  s_mov_b32 s24, s10
  s_and_b32 s25, s11, 0xffff
  s_mov_b32 s26, 268435456
  s_mov_b32 s27, 0x00020000
  s_cmp_eq_u32 s20, 7
  s_cbranch_scc1 F_AUX
  s_mov_b32 s12, s4
  s_and_b32 s13, s5, 0xffff
  s_mov_b32 s14, 67108864
  s_mov_b32 s15, 0x00020000
  s_mov_b32 s16, s6
  s_and_b32 s17, s7, 0xffff
  s_mov_b32 s18, 67108864
  s_mov_b32 s19, 0x00020000
  s_mov_b32 s43, 2147418112
  s_mov_b32 s40, 1069066811
  s_cmp_ge_u32 s20, 2
  s_cbranch_scc1 F_NI
  v_mov_b32 v12, -1
  v_mov_b32 v13, -1
  v_mov_b32 v14, -1
  v_mov_b32 v15, -1
  v_lshlrev_b32 v5, 4, v2
  s_cmp_eq_u32 s20, 1
  s_cbranch_scc1 F_I1
  s_lshr_b32 s41, s2, 5
  s_mul_i32 s41, s41, 46
  s_and_b32 s42, s2, 31
  s_add_u32 s41, s41, s42
  s_branch F_IS
F_I1:
  s_cmp_ge_u32 s2, 112
  s_cbranch_scc1 F_NI
  s_and_b32 s41, s2, 7
  s_mul_i32 s41, s41, 46
  s_lshr_b32 s42, s2, 3
  s_add_u32 s41, s41, s42
  s_add_u32 s41, s41, 32
F_IS:
  s_lshl_b32 s41, s41, 10
  s_add_u32 s41, s41, 524288
  buffer_store_dwordx4 v[12:15], v5, s[24:27], s41 offen
  s_nop 1
F_NI:
  s_min_u32 s34, s20, 4
  s_lshl_b32 s35, s20, 2
  s_add_u32 s34, s34, s35
  s_cmp_lt_u32 s20, 4
  s_cselect_b32 s22, 5, 4
  s_lshl_b32 s21, s86, 5
  s_add_u32 s21, s21, s34
  s_lshl_b32 s21, s21, 13
  s_lshr_b32 s34, s2, 3
  s_lshl_b32 s34, s34, 21
  s_add_u32 s21, s21, s34
  v_and_b32 v5, 7, v4
  v_lshlrev_b32 v5, 8, v5
  v_lshrrev_b32 v6, 3, v4
  v_lshl_add_u32 v6, v6, 2, v3
  v_lshl_add_u32 v5, v6, 4, v5
  v_lshlrev_b32 v6, 1, v3
  v_xor_b32 v7, v4, v6
  v_lshlrev_b32 v7, 4, v7
  v_lshl_add_u32 v7, v3, 8, v7
  v_xor_b32 v8, 0x80, v7
  s_lshl_b32 s34, s2, 3
  s_add_u32 s34, s34, s20
  s_mul_i32 s34, s34, 0x9E3779B1
  s_lshl_b32 s36, s22, 1
  s_mul_hi_u32 s34, s34, s36
  s_add_u32 s35, s34, 0
  s_cmp_ge_u32 s35, s36
  s_cselect_b32 s37, s36, 0
  s_sub_u32 s35, s35, s37
  s_lshl_b32 s35, s35, 12
  s_add_u32 s35, s35, s21
  s_cmp_lt_u32 0, s36
  s_cselect_b32 s64, s35, s43
  s_add_u32 s35, s34, 1
  s_cmp_ge_u32 s35, s36
  s_cselect_b32 s37, s36, 0
  s_sub_u32 s35, s35, s37
  s_lshl_b32 s35, s35, 12
  s_add_u32 s35, s35, s21
  s_cmp_lt_u32 1, s36
  s_cselect_b32 s65, s35, s43
  s_add_u32 s35, s34, 2
  s_cmp_ge_u32 s35, s36
  s_cselect_b32 s37, s36, 0
  s_sub_u32 s35, s35, s37
  s_lshl_b32 s35, s35, 12
  s_add_u32 s35, s35, s21
  s_cmp_lt_u32 2, s36
  s_cselect_b32 s66, s35, s43
  s_add_u32 s35, s34, 3
  s_cmp_ge_u32 s35, s36
  s_cselect_b32 s37, s36, 0
  s_sub_u32 s35, s35, s37
  s_lshl_b32 s35, s35, 12
  s_add_u32 s35, s35, s21
  s_cmp_lt_u32 3, s36
  s_cselect_b32 s67, s35, s43
  s_add_u32 s35, s34, 4
  s_cmp_ge_u32 s35, s36
  s_cselect_b32 s37, s36, 0
  s_sub_u32 s35, s35, s37
  s_lshl_b32 s35, s35, 12
  s_add_u32 s35, s35, s21
  s_cmp_lt_u32 4, s36
  s_cselect_b32 s68, s35, s43
  s_add_u32 s35, s34, 5
  s_cmp_ge_u32 s35, s36
  s_cselect_b32 s37, s36, 0
  s_sub_u32 s35, s35, s37
  s_lshl_b32 s35, s35, 12
  s_add_u32 s35, s35, s21
  s_cmp_lt_u32 5, s36
  s_cselect_b32 s69, s35, s43
  s_add_u32 s35, s34, 6
  s_cmp_ge_u32 s35, s36
  s_cselect_b32 s37, s36, 0
  s_sub_u32 s35, s35, s37
  s_lshl_b32 s35, s35, 12
  s_add_u32 s35, s35, s21
  s_cmp_lt_u32 6, s36
  s_cselect_b32 s70, s35, s43
  s_add_u32 s35, s34, 7
  s_cmp_ge_u32 s35, s36
  s_cselect_b32 s37, s36, 0
  s_sub_u32 s35, s35, s37
  s_lshl_b32 s35, s35, 12
  s_add_u32 s35, s35, s21
  s_cmp_lt_u32 7, s36
  s_cselect_b32 s71, s35, s43
  s_add_u32 s35, s34, 8
  s_cmp_ge_u32 s35, s36
  s_cselect_b32 s37, s36, 0
  s_sub_u32 s35, s35, s37
  s_lshl_b32 s35, s35, 12
  s_add_u32 s35, s35, s21
  s_cmp_lt_u32 8, s36
  s_cselect_b32 s72, s35, s43
  s_add_u32 s35, s34, 9
  s_cmp_ge_u32 s35, s36
  s_cselect_b32 s37, s36, 0
  s_sub_u32 s35, s35, s37
  s_lshl_b32 s35, s35, 12
  s_add_u32 s35, s35, s21
  s_cmp_lt_u32 9, s36
  s_cselect_b32 s73, s35, s43
  s_barrier
  buffer_load_dwordx4 v[64:67], v5, s[12:15], s64 offen offset:0 nt
  buffer_load_dwordx4 v[68:71], v5, s[12:15], s64 offen offset:128 nt
  buffer_load_dwordx4 v[72:75], v5, s[12:15], s64 offen offset:2048 nt
  buffer_load_dwordx4 v[76:79], v5, s[12:15], s64 offen offset:2176 nt
  buffer_load_dwordx4 v[80:83], v5, s[12:15], s65 offen offset:0 nt
  buffer_load_dwordx4 v[84:87], v5, s[12:15], s65 offen offset:128 nt
  buffer_load_dwordx4 v[88:91], v5, s[12:15], s65 offen offset:2048 nt
  buffer_load_dwordx4 v[92:95], v5, s[12:15], s65 offen offset:2176 nt
  s_add_u32 m0, s23, 0
  s_nop 0
  s_waitcnt vmcnt(7)
  buffer_load_dwordx4 v7, s[16:19], s64 offen offset:0 nt lds
  s_waitcnt vmcnt(7)
  buffer_load_dwordx4 v8, s[16:19], s64 offen offset:1024 nt lds
  s_waitcnt vmcnt(7)
  buffer_load_dwordx4 v7, s[16:19], s64 offen offset:2048 nt lds
  s_waitcnt vmcnt(7)
  buffer_load_dwordx4 v8, s[16:19], s64 offen offset:3072 nt lds
  s_add_u32 m0, s23, 4096
  s_nop 0
  s_waitcnt vmcnt(7)
  buffer_load_dwordx4 v7, s[16:19], s65 offen offset:0 nt lds
  s_waitcnt vmcnt(7)
  buffer_load_dwordx4 v8, s[16:19], s65 offen offset:1024 nt lds
  s_waitcnt vmcnt(7)
  buffer_load_dwordx4 v7, s[16:19], s65 offen offset:2048 nt lds
  s_waitcnt vmcnt(7)
  buffer_load_dwordx4 v8, s[16:19], s65 offen offset:3072 nt lds
  s_waitcnt vmcnt(7)
  buffer_load_dwordx4 v[96:99], v5, s[12:15], s66 offen offset:0 nt
  s_waitcnt vmcnt(7)
  buffer_load_dwordx4 v[100:103], v5, s[12:15], s66 offen offset:128 nt
  s_waitcnt vmcnt(7)
  buffer_load_dwordx4 v[104:107], v5, s[12:15], s66 offen offset:2048 nt
  s_waitcnt vmcnt(7)
  buffer_load_dwordx4 v[108:111], v5, s[12:15], s66 offen offset:2176 nt
  s_waitcnt vmcnt(7)
  buffer_load_dwordx4 v[112:115], v5, s[12:15], s67 offen offset:0 nt
  s_waitcnt vmcnt(7)
  buffer_load_dwordx4 v[116:119], v5, s[12:15], s67 offen offset:128 nt
  s_waitcnt vmcnt(7)
  buffer_load_dwordx4 v[120:123], v5, s[12:15], s67 offen offset:2048 nt
  s_waitcnt vmcnt(7)
  buffer_load_dwordx4 v[124:127], v5, s[12:15], s67 offen offset:2176 nt
  s_add_u32 m0, s23, 8192
  s_nop 0
  s_waitcnt vmcnt(7)
  buffer_load_dwordx4 v7, s[16:19], s66 offen offset:0 nt lds
  s_waitcnt vmcnt(7)
  buffer_load_dwordx4 v8, s[16:19], s66 offen offset:1024 nt lds
  s_waitcnt vmcnt(7)
  buffer_load_dwordx4 v7, s[16:19], s66 offen offset:2048 nt lds
  s_waitcnt vmcnt(7)
  buffer_load_dwordx4 v8, s[16:19], s66 offen offset:3072 nt lds
  s_add_u32 m0, s23, 12288
  s_nop 0
  s_waitcnt vmcnt(7)
  buffer_load_dwordx4 v7, s[16:19], s67 offen offset:0 nt lds
  s_waitcnt vmcnt(7)
  buffer_load_dwordx4 v8, s[16:19], s67 offen offset:1024 nt lds
  s_waitcnt vmcnt(7)
  buffer_load_dwordx4 v7, s[16:19], s67 offen offset:2048 nt lds
  s_waitcnt vmcnt(7)
  buffer_load_dwordx4 v8, s[16:19], s67 offen offset:3072 nt lds
  s_waitcnt vmcnt(7)
  buffer_load_dwordx4 v[128:131], v5, s[12:15], s68 offen offset:0 nt
  s_waitcnt vmcnt(7)
  buffer_load_dwordx4 v[132:135], v5, s[12:15], s68 offen offset:128 nt
  s_waitcnt vmcnt(7)
  buffer_load_dwordx4 v[136:139], v5, s[12:15], s68 offen offset:2048 nt
  s_waitcnt vmcnt(7)
  buffer_load_dwordx4 v[140:143], v5, s[12:15], s68 offen offset:2176 nt
  s_waitcnt vmcnt(7)
  buffer_load_dwordx4 v[144:147], v5, s[12:15], s69 offen offset:0 nt
  s_waitcnt vmcnt(7)
  buffer_load_dwordx4 v[148:151], v5, s[12:15], s69 offen offset:128 nt
  s_waitcnt vmcnt(7)
  buffer_load_dwordx4 v[152:155], v5, s[12:15], s69 offen offset:2048 nt
  s_waitcnt vmcnt(7)
  buffer_load_dwordx4 v[156:159], v5, s[12:15], s69 offen offset:2176 nt
  s_waitcnt vmcnt(7)
  buffer_load_dwordx4 v[160:163], v5, s[12:15], s70 offen offset:0 nt
  s_waitcnt vmcnt(7)
  buffer_load_dwordx4 v[164:167], v5, s[12:15], s70 offen offset:128 nt
  s_waitcnt vmcnt(7)
  buffer_load_dwordx4 v[168:171], v5, s[12:15], s70 offen offset:2048 nt
  s_waitcnt vmcnt(7)
  buffer_load_dwordx4 v[172:175], v5, s[12:15], s70 offen offset:2176 nt
  s_waitcnt vmcnt(7)
  buffer_load_dwordx4 v[176:179], v5, s[12:15], s71 offen offset:0 nt
  s_waitcnt vmcnt(7)
  buffer_load_dwordx4 v[180:183], v5, s[12:15], s71 offen offset:128 nt
  s_waitcnt vmcnt(7)
  buffer_load_dwordx4 v[184:187], v5, s[12:15], s71 offen offset:2048 nt
  s_waitcnt vmcnt(7)
  buffer_load_dwordx4 v[188:191], v5, s[12:15], s71 offen offset:2176 nt
  v_lshrrev_b32 v10, 2, v4
  v_and_b32 v11, 3, v4
  v_lshl_add_u32 v12, v3, 2, v10
  v_and_b32 v13, 7, v12
  v_lshlrev_b32 v12, 8, v12
  v_lshl_add_u32 v12, v11, 3, v12
  v_add_u32 v12, s23, v12
  v_xor_b32 v14, 0, v13
  v_lshl_add_u32 v40, v14, 5, v12
  v_xor_b32 v14, 1, v13
  v_lshl_add_u32 v41, v14, 5, v12
  v_xor_b32 v14, 2, v13
  v_lshl_add_u32 v42, v14, 5, v12
  v_xor_b32 v14, 3, v13
  v_lshl_add_u32 v43, v14, 5, v12
  v_xor_b32 v14, 4, v13
  v_lshl_add_u32 v44, v14, 5, v12
  v_xor_b32 v14, 5, v13
  v_lshl_add_u32 v45, v14, 5, v12
  v_xor_b32 v14, 6, v13
  v_lshl_add_u32 v46, v14, 5, v12
  v_xor_b32 v14, 7, v13
  v_lshl_add_u32 v47, v14, 5, v12
  s_mov_b32 s41, 1035273459
  s_mov_b32 s42, 0xffff0000
  s_barrier
  v_lshlrev_b32 v9, 8, v11
  v_and_b32 v14, 1, v10
  v_lshl_add_u32 v9, v14, 6, v9
  v_lshl_add_u32 v9, v3, 4, v9
  v_add_u32 v9, 131072, v9
  ds_read_b128 v[16:19], v9 offset:0
  ds_read_b128 v[20:23], v9 offset:128
  s_waitcnt lgkmcnt(0)
  s_waitcnt vmcnt(40)
  v_mfma_f32_16x16x32_bf16 v[24:27], v[64:67], v[16:19], 0
  v_mfma_f32_16x16x32_bf16 v[24:27], v[68:71], v[20:23], v[24:27]
  v_mfma_f32_16x16x32_bf16 v[28:31], v[72:75], v[16:19], 0
  v_mfma_f32_16x16x32_bf16 v[28:31], v[76:79], v[20:23], v[28:31]
  v_mfma_f32_16x16x32_bf16 v[56:59], v[80:83], v[16:19], 0
  v_mfma_f32_16x16x32_bf16 v[56:59], v[84:87], v[20:23], v[56:59]
  v_mfma_f32_16x16x32_bf16 v[60:63], v[88:91], v[16:19], 0
  v_mfma_f32_16x16x32_bf16 v[60:63], v[92:95], v[20:23], v[60:63]
  s_nop 7
  buffer_load_dwordx4 v[64:67], v5, s[12:15], s72 offen offset:0 nt
  buffer_load_dwordx4 v[68:71], v5, s[12:15], s72 offen offset:128 nt
  buffer_load_dwordx4 v[72:75], v5, s[12:15], s72 offen offset:2048 nt
  buffer_load_dwordx4 v[76:79], v5, s[12:15], s72 offen offset:2176 nt
  buffer_load_dwordx4 v[80:83], v5, s[12:15], s73 offen offset:0 nt
  buffer_load_dwordx4 v[84:87], v5, s[12:15], s73 offen offset:128 nt
  buffer_load_dwordx4 v[88:91], v5, s[12:15], s73 offen offset:2048 nt
  buffer_load_dwordx4 v[92:95], v5, s[12:15], s73 offen offset:2176 nt
  v_permlane32_swap_b32 v24, v28
  v_permlane32_swap_b32 v25, v29
  v_permlane32_swap_b32 v26, v30
  v_permlane32_swap_b32 v27, v31
  v_permlane32_swap_b32 v56, v60
  v_permlane32_swap_b32 v57, v61
  v_permlane32_swap_b32 v58, v62
  v_permlane32_swap_b32 v59, v63
  s_nop 1
  v_add_f32_dpp v48, v28, v24 row_shl:4 row_mask:0xf bank_mask:0xf bound_ctrl:1
  v_add_f32_dpp v49, v29, v25 row_shl:4 row_mask:0xf bank_mask:0xf bound_ctrl:1
  v_add_f32_dpp v50, v30, v26 row_shl:4 row_mask:0xf bank_mask:0xf bound_ctrl:1
  v_add_f32_dpp v51, v31, v27 row_shl:4 row_mask:0xf bank_mask:0xf bound_ctrl:1
  v_add_f32_dpp v52, v60, v56 row_shl:4 row_mask:0xf bank_mask:0xf bound_ctrl:1
  v_add_f32_dpp v53, v61, v57 row_shl:4 row_mask:0xf bank_mask:0xf bound_ctrl:1
  v_add_f32_dpp v54, v62, v58 row_shl:4 row_mask:0xf bank_mask:0xf bound_ctrl:1
  v_add_f32_dpp v55, v63, v59 row_shl:4 row_mask:0xf bank_mask:0xf bound_ctrl:1
  v_cvt_pk_bf16_f32 v12, v48, v49
  v_lshlrev_b32 v48, 16, v12
  v_and_b32 v49, s42, v12
  v_mul_f32 v48, s41, v48
  v_mul_f32 v49, s41, v49
  v_cvt_pk_bf16_f32 v12, v48, v49
  v_lshlrev_b32 v48, 16, v12
  v_and_b32 v49, s42, v12
  v_cvt_pk_bf16_f32 v12, v50, v51
  v_lshlrev_b32 v50, 16, v12
  v_and_b32 v51, s42, v12
  v_mul_f32 v50, s41, v50
  v_mul_f32 v51, s41, v51
  v_cvt_pk_bf16_f32 v12, v50, v51
  v_lshlrev_b32 v50, 16, v12
  v_and_b32 v51, s42, v12
  v_cvt_pk_bf16_f32 v12, v52, v53
  v_lshlrev_b32 v52, 16, v12
  v_and_b32 v53, s42, v12
  v_mul_f32 v52, s41, v52
  v_mul_f32 v53, s41, v53
  v_cvt_pk_bf16_f32 v12, v52, v53
  v_lshlrev_b32 v52, 16, v12
  v_and_b32 v53, s42, v12
  v_cvt_pk_bf16_f32 v12, v54, v55
  v_lshlrev_b32 v54, 16, v12
  v_and_b32 v55, s42, v12
  v_mul_f32 v54, s41, v54
  v_mul_f32 v55, s41, v55
  v_cvt_pk_bf16_f32 v12, v54, v55
  v_lshlrev_b32 v54, 16, v12
  v_and_b32 v55, s42, v12
  v_max3_f32 v12, v48, v49, v50
  v_max3_f32 v12, v12, v51, v52
  v_max3_f32 v12, v12, v53, v54
  v_max_f32 v12, v12, v55
  v_mov_b32 v13, v12
  s_nop 1
  v_permlane32_swap_b32 v12, v13
  s_nop 1
  v_max_f32 v12, v12, v13
  v_mov_b32 v13, v12
  s_nop 1
  v_permlane16_swap_b32 v12, v13
  s_nop 1
  v_max_f32 v12, v12, v13
  v_mov_b32 v10, v12
  v_sub_f32 v48, v48, v10
  v_sub_f32 v49, v49, v10
  v_sub_f32 v50, v50, v10
  v_sub_f32 v51, v51, v10
  v_sub_f32 v52, v52, v10
  v_sub_f32 v53, v53, v10
  v_sub_f32 v54, v54, v10
  v_sub_f32 v55, v55, v10
  v_mul_f32 v48, s40, v48
  v_mul_f32 v49, s40, v49
  v_mul_f32 v50, s40, v50
  v_mul_f32 v51, s40, v51
  v_mul_f32 v52, s40, v52
  v_mul_f32 v53, s40, v53
  v_mul_f32 v54, s40, v54
  v_mul_f32 v55, s40, v55
  v_exp_f32 v48, v48
  v_exp_f32 v49, v49
  v_exp_f32 v50, v50
  v_exp_f32 v51, v51
  v_exp_f32 v52, v52
  v_exp_f32 v53, v53
  v_exp_f32 v54, v54
  v_exp_f32 v55, v55
  s_nop 0
  v_add_f32 v11, v48, v49
  v_add_f32 v11, v11, v50
  v_add_f32 v11, v11, v51
  v_add_f32 v11, v11, v52
  v_add_f32 v11, v11, v53
  v_add_f32 v11, v11, v54
  v_add_f32 v11, v11, v55
  v_cvt_pk_bf16_f32 v32, v48, v49
  v_cvt_pk_bf16_f32 v33, v50, v51
  v_cvt_pk_bf16_f32 v34, v52, v53
  v_cvt_pk_bf16_f32 v35, v54, v55
  s_waitcnt vmcnt(40)
  ds_read_b64_tr_b16 v[48:49], v40 offset:0
  ds_read_b64_tr_b16 v[50:51], v40 offset:4096
  ds_read_b64_tr_b16 v[52:53], v41 offset:0
  ds_read_b64_tr_b16 v[54:55], v41 offset:4096
  ds_read_b64_tr_b16 v[56:57], v42 offset:0
  ds_read_b64_tr_b16 v[58:59], v42 offset:4096
  ds_read_b64_tr_b16 v[60:61], v43 offset:0
  ds_read_b64_tr_b16 v[62:63], v43 offset:4096
  s_waitcnt lgkmcnt(6)
  v_mfma_f32_16x16x32_bf16 v[192:195], v[48:51], v[32:35], 0
  s_waitcnt lgkmcnt(4)
  v_mfma_f32_16x16x32_bf16 v[196:199], v[52:55], v[32:35], 0
  s_waitcnt lgkmcnt(2)
  v_mfma_f32_16x16x32_bf16 v[200:203], v[56:59], v[32:35], 0
  s_waitcnt lgkmcnt(0)
  v_mfma_f32_16x16x32_bf16 v[204:207], v[60:63], v[32:35], 0
  s_nop 7
  ds_read_b64_tr_b16 v[48:49], v44 offset:0
  ds_read_b64_tr_b16 v[50:51], v44 offset:4096
  ds_read_b64_tr_b16 v[52:53], v45 offset:0
  ds_read_b64_tr_b16 v[54:55], v45 offset:4096
  ds_read_b64_tr_b16 v[56:57], v46 offset:0
  ds_read_b64_tr_b16 v[58:59], v46 offset:4096
  ds_read_b64_tr_b16 v[60:61], v47 offset:0
  ds_read_b64_tr_b16 v[62:63], v47 offset:4096
  s_waitcnt lgkmcnt(6)
  v_mfma_f32_16x16x32_bf16 v[208:211], v[48:51], v[32:35], 0
  s_waitcnt lgkmcnt(4)
  v_mfma_f32_16x16x32_bf16 v[212:215], v[52:55], v[32:35], 0
  s_waitcnt lgkmcnt(2)
  v_mfma_f32_16x16x32_bf16 v[216:219], v[56:59], v[32:35], 0
  s_waitcnt lgkmcnt(0)
  v_mfma_f32_16x16x32_bf16 v[220:223], v[60:63], v[32:35], 0
  s_add_u32 m0, s23, 0
  s_nop 0
  buffer_load_dwordx4 v7, s[16:19], s68 offen offset:0 nt lds
  buffer_load_dwordx4 v8, s[16:19], s68 offen offset:1024 nt lds
  buffer_load_dwordx4 v7, s[16:19], s68 offen offset:2048 nt lds
  buffer_load_dwordx4 v8, s[16:19], s68 offen offset:3072 nt lds
  s_add_u32 m0, s23, 4096
  s_nop 0
  buffer_load_dwordx4 v7, s[16:19], s69 offen offset:0 nt lds
  buffer_load_dwordx4 v8, s[16:19], s69 offen offset:1024 nt lds
  buffer_load_dwordx4 v7, s[16:19], s69 offen offset:2048 nt lds
  buffer_load_dwordx4 v8, s[16:19], s69 offen offset:3072 nt lds
  s_nop 7
  s_waitcnt vmcnt(40)
  v_mfma_f32_16x16x32_bf16 v[24:27], v[96:99], v[16:19], 0
  v_mfma_f32_16x16x32_bf16 v[24:27], v[100:103], v[20:23], v[24:27]
  v_mfma_f32_16x16x32_bf16 v[28:31], v[104:107], v[16:19], 0
  v_mfma_f32_16x16x32_bf16 v[28:31], v[108:111], v[20:23], v[28:31]
  v_mfma_f32_16x16x32_bf16 v[56:59], v[112:115], v[16:19], 0
  v_mfma_f32_16x16x32_bf16 v[56:59], v[116:119], v[20:23], v[56:59]
  v_mfma_f32_16x16x32_bf16 v[60:63], v[120:123], v[16:19], 0
  v_mfma_f32_16x16x32_bf16 v[60:63], v[124:127], v[20:23], v[60:63]
  s_nop 7
  s_nop 3
  v_permlane32_swap_b32 v24, v28
  v_permlane32_swap_b32 v25, v29
  v_permlane32_swap_b32 v26, v30
  v_permlane32_swap_b32 v27, v31
  v_permlane32_swap_b32 v56, v60
  v_permlane32_swap_b32 v57, v61
  v_permlane32_swap_b32 v58, v62
  v_permlane32_swap_b32 v59, v63
  s_nop 1
  v_add_f32_dpp v48, v28, v24 row_shl:4 row_mask:0xf bank_mask:0xf bound_ctrl:1
  v_add_f32_dpp v49, v29, v25 row_shl:4 row_mask:0xf bank_mask:0xf bound_ctrl:1
  v_add_f32_dpp v50, v30, v26 row_shl:4 row_mask:0xf bank_mask:0xf bound_ctrl:1
  v_add_f32_dpp v51, v31, v27 row_shl:4 row_mask:0xf bank_mask:0xf bound_ctrl:1
  v_add_f32_dpp v52, v60, v56 row_shl:4 row_mask:0xf bank_mask:0xf bound_ctrl:1
  v_add_f32_dpp v53, v61, v57 row_shl:4 row_mask:0xf bank_mask:0xf bound_ctrl:1
  v_add_f32_dpp v54, v62, v58 row_shl:4 row_mask:0xf bank_mask:0xf bound_ctrl:1
  v_add_f32_dpp v55, v63, v59 row_shl:4 row_mask:0xf bank_mask:0xf bound_ctrl:1
  v_cvt_pk_bf16_f32 v12, v48, v49
  v_lshlrev_b32 v48, 16, v12
  v_and_b32 v49, s42, v12
  v_mul_f32 v48, s41, v48
  v_mul_f32 v49, s41, v49
  v_cvt_pk_bf16_f32 v12, v48, v49
  v_lshlrev_b32 v48, 16, v12
  v_and_b32 v49, s42, v12
  v_cvt_pk_bf16_f32 v12, v50, v51
  v_lshlrev_b32 v50, 16, v12
  v_and_b32 v51, s42, v12
  v_mul_f32 v50, s41, v50
  v_mul_f32 v51, s41, v51
  v_cvt_pk_bf16_f32 v12, v50, v51
  v_lshlrev_b32 v50, 16, v12
  v_and_b32 v51, s42, v12
  v_cvt_pk_bf16_f32 v12, v52, v53
  v_lshlrev_b32 v52, 16, v12
  v_and_b32 v53, s42, v12
  v_mul_f32 v52, s41, v52
  v_mul_f32 v53, s41, v53
  v_cvt_pk_bf16_f32 v12, v52, v53
  v_lshlrev_b32 v52, 16, v12
  v_and_b32 v53, s42, v12
  v_cvt_pk_bf16_f32 v12, v54, v55
  v_lshlrev_b32 v54, 16, v12
  v_and_b32 v55, s42, v12
  v_mul_f32 v54, s41, v54
  v_mul_f32 v55, s41, v55
  v_cvt_pk_bf16_f32 v12, v54, v55
  v_lshlrev_b32 v54, 16, v12
  v_and_b32 v55, s42, v12
  v_max3_f32 v12, v48, v49, v50
  v_max3_f32 v12, v12, v51, v52
  v_max3_f32 v12, v12, v53, v54
  v_max_f32 v12, v12, v55
  v_mov_b32 v13, v12
  s_nop 1
  v_permlane32_swap_b32 v12, v13
  s_nop 1
  v_max_f32 v12, v12, v13
  v_mov_b32 v13, v12
  s_nop 1
  v_permlane16_swap_b32 v12, v13
  s_nop 1
  v_max_f32 v12, v12, v13
  v_max_f32 v12, v12, v10
  v_sub_f32 v14, v10, v12
  v_mul_f32 v14, s40, v14
  v_exp_f32 v14, v14
  v_mov_b32 v10, v12
  v_sub_f32 v48, v48, v10
  v_sub_f32 v49, v49, v10
  v_sub_f32 v50, v50, v10
  v_sub_f32 v51, v51, v10
  v_sub_f32 v52, v52, v10
  v_sub_f32 v53, v53, v10
  v_sub_f32 v54, v54, v10
  v_sub_f32 v55, v55, v10
  v_mul_f32 v48, s40, v48
  v_mul_f32 v49, s40, v49
  v_mul_f32 v50, s40, v50
  v_mul_f32 v51, s40, v51
  v_mul_f32 v52, s40, v52
  v_mul_f32 v53, s40, v53
  v_mul_f32 v54, s40, v54
  v_mul_f32 v55, s40, v55
  v_exp_f32 v48, v48
  v_exp_f32 v49, v49
  v_exp_f32 v50, v50
  v_exp_f32 v51, v51
  v_exp_f32 v52, v52
  v_exp_f32 v53, v53
  v_exp_f32 v54, v54
  v_exp_f32 v55, v55
  s_nop 0
  v_fma_f32 v11, v11, v14, v48
  v_mul_f32 v192, v192, v14
  v_mul_f32 v193, v193, v14
  v_mul_f32 v194, v194, v14
  v_mul_f32 v195, v195, v14
  v_mul_f32 v196, v196, v14
  v_mul_f32 v197, v197, v14
  v_mul_f32 v198, v198, v14
  v_mul_f32 v199, v199, v14
  v_mul_f32 v200, v200, v14
  v_mul_f32 v201, v201, v14
  v_mul_f32 v202, v202, v14
  v_mul_f32 v203, v203, v14
  v_mul_f32 v204, v204, v14
  v_mul_f32 v205, v205, v14
  v_mul_f32 v206, v206, v14
  v_mul_f32 v207, v207, v14
  v_mul_f32 v208, v208, v14
  v_mul_f32 v209, v209, v14
  v_mul_f32 v210, v210, v14
  v_mul_f32 v211, v211, v14
  v_mul_f32 v212, v212, v14
  v_mul_f32 v213, v213, v14
  v_mul_f32 v214, v214, v14
  v_mul_f32 v215, v215, v14
  v_mul_f32 v216, v216, v14
  v_mul_f32 v217, v217, v14
  v_mul_f32 v218, v218, v14
  v_mul_f32 v219, v219, v14
  v_mul_f32 v220, v220, v14
  v_mul_f32 v221, v221, v14
  v_mul_f32 v222, v222, v14
  v_mul_f32 v223, v223, v14
  v_add_f32 v11, v11, v49
  v_add_f32 v11, v11, v50
  v_add_f32 v11, v11, v51
  v_add_f32 v11, v11, v52
  v_add_f32 v11, v11, v53
  v_add_f32 v11, v11, v54
  v_add_f32 v11, v11, v55
  v_cvt_pk_bf16_f32 v32, v48, v49
  v_cvt_pk_bf16_f32 v33, v50, v51
  v_cvt_pk_bf16_f32 v34, v52, v53
  v_cvt_pk_bf16_f32 v35, v54, v55
  s_waitcnt vmcnt(32)
  ds_read_b64_tr_b16 v[48:49], v40 offset:8192
  ds_read_b64_tr_b16 v[50:51], v40 offset:12288
  ds_read_b64_tr_b16 v[52:53], v41 offset:8192
  ds_read_b64_tr_b16 v[54:55], v41 offset:12288
  ds_read_b64_tr_b16 v[56:57], v42 offset:8192
  ds_read_b64_tr_b16 v[58:59], v42 offset:12288
  ds_read_b64_tr_b16 v[60:61], v43 offset:8192
  ds_read_b64_tr_b16 v[62:63], v43 offset:12288
  s_waitcnt lgkmcnt(6)
  v_mfma_f32_16x16x32_bf16 v[192:195], v[48:51], v[32:35], v[192:195]
  s_waitcnt lgkmcnt(4)
  v_mfma_f32_16x16x32_bf16 v[196:199], v[52:55], v[32:35], v[196:199]
  s_waitcnt lgkmcnt(2)
  v_mfma_f32_16x16x32_bf16 v[200:203], v[56:59], v[32:35], v[200:203]
  s_waitcnt lgkmcnt(0)
  v_mfma_f32_16x16x32_bf16 v[204:207], v[60:63], v[32:35], v[204:207]
  s_nop 7
  ds_read_b64_tr_b16 v[48:49], v44 offset:8192
  ds_read_b64_tr_b16 v[50:51], v44 offset:12288
  ds_read_b64_tr_b16 v[52:53], v45 offset:8192
  ds_read_b64_tr_b16 v[54:55], v45 offset:12288
  ds_read_b64_tr_b16 v[56:57], v46 offset:8192
  ds_read_b64_tr_b16 v[58:59], v46 offset:12288
  ds_read_b64_tr_b16 v[60:61], v47 offset:8192
  ds_read_b64_tr_b16 v[62:63], v47 offset:12288
  s_waitcnt lgkmcnt(6)
  v_mfma_f32_16x16x32_bf16 v[208:211], v[48:51], v[32:35], v[208:211]
  s_waitcnt lgkmcnt(4)
  v_mfma_f32_16x16x32_bf16 v[212:215], v[52:55], v[32:35], v[212:215]
  s_waitcnt lgkmcnt(2)
  v_mfma_f32_16x16x32_bf16 v[216:219], v[56:59], v[32:35], v[216:219]
  s_waitcnt lgkmcnt(0)
  v_mfma_f32_16x16x32_bf16 v[220:223], v[60:63], v[32:35], v[220:223]
  s_add_u32 m0, s23, 8192
  s_nop 0
  buffer_load_dwordx4 v7, s[16:19], s70 offen offset:0 nt lds
  buffer_load_dwordx4 v8, s[16:19], s70 offen offset:1024 nt lds
  buffer_load_dwordx4 v7, s[16:19], s70 offen offset:2048 nt lds
  buffer_load_dwordx4 v8, s[16:19], s70 offen offset:3072 nt lds
  s_add_u32 m0, s23, 12288
  s_nop 0
  buffer_load_dwordx4 v7, s[16:19], s71 offen offset:0 nt lds
  buffer_load_dwordx4 v8, s[16:19], s71 offen offset:1024 nt lds
  buffer_load_dwordx4 v7, s[16:19], s71 offen offset:2048 nt lds
  buffer_load_dwordx4 v8, s[16:19], s71 offen offset:3072 nt lds
  s_nop 7
  s_waitcnt vmcnt(32)
  v_mfma_f32_16x16x32_bf16 v[24:27], v[128:131], v[16:19], 0
  v_mfma_f32_16x16x32_bf16 v[24:27], v[132:135], v[20:23], v[24:27]
  v_mfma_f32_16x16x32_bf16 v[28:31], v[136:139], v[16:19], 0
  v_mfma_f32_16x16x32_bf16 v[28:31], v[140:143], v[20:23], v[28:31]
  v_mfma_f32_16x16x32_bf16 v[56:59], v[144:147], v[16:19], 0
  v_mfma_f32_16x16x32_bf16 v[56:59], v[148:151], v[20:23], v[56:59]
  v_mfma_f32_16x16x32_bf16 v[60:63], v[152:155], v[16:19], 0
  v_mfma_f32_16x16x32_bf16 v[60:63], v[156:159], v[20:23], v[60:63]
  s_nop 7
  s_nop 3
  v_permlane32_swap_b32 v24, v28
  v_permlane32_swap_b32 v25, v29
  v_permlane32_swap_b32 v26, v30
  v_permlane32_swap_b32 v27, v31
  v_permlane32_swap_b32 v56, v60
  v_permlane32_swap_b32 v57, v61
  v_permlane32_swap_b32 v58, v62
  v_permlane32_swap_b32 v59, v63
  s_nop 1
  v_add_f32_dpp v48, v28, v24 row_shl:4 row_mask:0xf bank_mask:0xf bound_ctrl:1
  v_add_f32_dpp v49, v29, v25 row_shl:4 row_mask:0xf bank_mask:0xf bound_ctrl:1
  v_add_f32_dpp v50, v30, v26 row_shl:4 row_mask:0xf bank_mask:0xf bound_ctrl:1
  v_add_f32_dpp v51, v31, v27 row_shl:4 row_mask:0xf bank_mask:0xf bound_ctrl:1
  v_add_f32_dpp v52, v60, v56 row_shl:4 row_mask:0xf bank_mask:0xf bound_ctrl:1
  v_add_f32_dpp v53, v61, v57 row_shl:4 row_mask:0xf bank_mask:0xf bound_ctrl:1
  v_add_f32_dpp v54, v62, v58 row_shl:4 row_mask:0xf bank_mask:0xf bound_ctrl:1
  v_add_f32_dpp v55, v63, v59 row_shl:4 row_mask:0xf bank_mask:0xf bound_ctrl:1
  v_cvt_pk_bf16_f32 v12, v48, v49
  v_lshlrev_b32 v48, 16, v12
  v_and_b32 v49, s42, v12
  v_mul_f32 v48, s41, v48
  v_mul_f32 v49, s41, v49
  v_cvt_pk_bf16_f32 v12, v48, v49
  v_lshlrev_b32 v48, 16, v12
  v_and_b32 v49, s42, v12
  v_cvt_pk_bf16_f32 v12, v50, v51
  v_lshlrev_b32 v50, 16, v12
  v_and_b32 v51, s42, v12
  v_mul_f32 v50, s41, v50
  v_mul_f32 v51, s41, v51
  v_cvt_pk_bf16_f32 v12, v50, v51
  v_lshlrev_b32 v50, 16, v12
  v_and_b32 v51, s42, v12
  v_cvt_pk_bf16_f32 v12, v52, v53
  v_lshlrev_b32 v52, 16, v12
  v_and_b32 v53, s42, v12
  v_mul_f32 v52, s41, v52
  v_mul_f32 v53, s41, v53
  v_cvt_pk_bf16_f32 v12, v52, v53
  v_lshlrev_b32 v52, 16, v12
  v_and_b32 v53, s42, v12
  v_cvt_pk_bf16_f32 v12, v54, v55
  v_lshlrev_b32 v54, 16, v12
  v_and_b32 v55, s42, v12
  v_mul_f32 v54, s41, v54
  v_mul_f32 v55, s41, v55
  v_cvt_pk_bf16_f32 v12, v54, v55
  v_lshlrev_b32 v54, 16, v12
  v_and_b32 v55, s42, v12
  v_max3_f32 v12, v48, v49, v50
  v_max3_f32 v12, v12, v51, v52
  v_max3_f32 v12, v12, v53, v54
  v_max_f32 v12, v12, v55
  v_mov_b32 v13, v12
  s_nop 1
  v_permlane32_swap_b32 v12, v13
  s_nop 1
  v_max_f32 v12, v12, v13
  v_mov_b32 v13, v12
  s_nop 1
  v_permlane16_swap_b32 v12, v13
  s_nop 1
  v_max_f32 v12, v12, v13
  v_max_f32 v12, v12, v10
  v_sub_f32 v14, v10, v12
  v_mul_f32 v14, s40, v14
  v_exp_f32 v14, v14
  v_mov_b32 v10, v12
  v_sub_f32 v48, v48, v10
  v_sub_f32 v49, v49, v10
  v_sub_f32 v50, v50, v10
  v_sub_f32 v51, v51, v10
  v_sub_f32 v52, v52, v10
  v_sub_f32 v53, v53, v10
  v_sub_f32 v54, v54, v10
  v_sub_f32 v55, v55, v10
  v_mul_f32 v48, s40, v48
  v_mul_f32 v49, s40, v49
  v_mul_f32 v50, s40, v50
  v_mul_f32 v51, s40, v51
  v_mul_f32 v52, s40, v52
  v_mul_f32 v53, s40, v53
  v_mul_f32 v54, s40, v54
  v_mul_f32 v55, s40, v55
  v_exp_f32 v48, v48
  v_exp_f32 v49, v49
  v_exp_f32 v50, v50
  v_exp_f32 v51, v51
  v_exp_f32 v52, v52
  v_exp_f32 v53, v53
  v_exp_f32 v54, v54
  v_exp_f32 v55, v55
  s_nop 0
  v_fma_f32 v11, v11, v14, v48
  v_mul_f32 v192, v192, v14
  v_mul_f32 v193, v193, v14
  v_mul_f32 v194, v194, v14
  v_mul_f32 v195, v195, v14
  v_mul_f32 v196, v196, v14
  v_mul_f32 v197, v197, v14
  v_mul_f32 v198, v198, v14
  v_mul_f32 v199, v199, v14
  v_mul_f32 v200, v200, v14
  v_mul_f32 v201, v201, v14
  v_mul_f32 v202, v202, v14
  v_mul_f32 v203, v203, v14
  v_mul_f32 v204, v204, v14
  v_mul_f32 v205, v205, v14
  v_mul_f32 v206, v206, v14
  v_mul_f32 v207, v207, v14
  v_mul_f32 v208, v208, v14
  v_mul_f32 v209, v209, v14
  v_mul_f32 v210, v210, v14
  v_mul_f32 v211, v211, v14
  v_mul_f32 v212, v212, v14
  v_mul_f32 v213, v213, v14
  v_mul_f32 v214, v214, v14
  v_mul_f32 v215, v215, v14
  v_mul_f32 v216, v216, v14
  v_mul_f32 v217, v217, v14
  v_mul_f32 v218, v218, v14
  v_mul_f32 v219, v219, v14
  v_mul_f32 v220, v220, v14
  v_mul_f32 v221, v221, v14
  v_mul_f32 v222, v222, v14
  v_mul_f32 v223, v223, v14
  v_add_f32 v11, v11, v49
  v_add_f32 v11, v11, v50
  v_add_f32 v11, v11, v51
  v_add_f32 v11, v11, v52
  v_add_f32 v11, v11, v53
  v_add_f32 v11, v11, v54
  v_add_f32 v11, v11, v55
  v_cvt_pk_bf16_f32 v32, v48, v49
  v_cvt_pk_bf16_f32 v33, v50, v51
  v_cvt_pk_bf16_f32 v34, v52, v53
  v_cvt_pk_bf16_f32 v35, v54, v55
  s_waitcnt vmcnt(8)
  ds_read_b64_tr_b16 v[48:49], v40 offset:0
  ds_read_b64_tr_b16 v[50:51], v40 offset:4096
  ds_read_b64_tr_b16 v[52:53], v41 offset:0
  ds_read_b64_tr_b16 v[54:55], v41 offset:4096
  ds_read_b64_tr_b16 v[56:57], v42 offset:0
  ds_read_b64_tr_b16 v[58:59], v42 offset:4096
  ds_read_b64_tr_b16 v[60:61], v43 offset:0
  ds_read_b64_tr_b16 v[62:63], v43 offset:4096
  s_waitcnt lgkmcnt(6)
  v_mfma_f32_16x16x32_bf16 v[192:195], v[48:51], v[32:35], v[192:195]
  s_waitcnt lgkmcnt(4)
  v_mfma_f32_16x16x32_bf16 v[196:199], v[52:55], v[32:35], v[196:199]
  s_waitcnt lgkmcnt(2)
  v_mfma_f32_16x16x32_bf16 v[200:203], v[56:59], v[32:35], v[200:203]
  s_waitcnt lgkmcnt(0)
  v_mfma_f32_16x16x32_bf16 v[204:207], v[60:63], v[32:35], v[204:207]
  s_nop 7
  ds_read_b64_tr_b16 v[48:49], v44 offset:0
  ds_read_b64_tr_b16 v[50:51], v44 offset:4096
  ds_read_b64_tr_b16 v[52:53], v45 offset:0
  ds_read_b64_tr_b16 v[54:55], v45 offset:4096
  ds_read_b64_tr_b16 v[56:57], v46 offset:0
  ds_read_b64_tr_b16 v[58:59], v46 offset:4096
  ds_read_b64_tr_b16 v[60:61], v47 offset:0
  ds_read_b64_tr_b16 v[62:63], v47 offset:4096
  s_waitcnt lgkmcnt(6)
  v_mfma_f32_16x16x32_bf16 v[208:211], v[48:51], v[32:35], v[208:211]
  s_waitcnt lgkmcnt(4)
  v_mfma_f32_16x16x32_bf16 v[212:215], v[52:55], v[32:35], v[212:215]
  s_waitcnt lgkmcnt(2)
  v_mfma_f32_16x16x32_bf16 v[216:219], v[56:59], v[32:35], v[216:219]
  s_waitcnt lgkmcnt(0)
  v_mfma_f32_16x16x32_bf16 v[220:223], v[60:63], v[32:35], v[220:223]
  s_add_u32 m0, s23, 0
  s_nop 0
  buffer_load_dwordx4 v7, s[16:19], s72 offen offset:0 nt lds
  buffer_load_dwordx4 v8, s[16:19], s72 offen offset:1024 nt lds
  buffer_load_dwordx4 v7, s[16:19], s72 offen offset:2048 nt lds
  buffer_load_dwordx4 v8, s[16:19], s72 offen offset:3072 nt lds
  s_add_u32 m0, s23, 4096
  s_nop 0
  buffer_load_dwordx4 v7, s[16:19], s73 offen offset:0 nt lds
  buffer_load_dwordx4 v8, s[16:19], s73 offen offset:1024 nt lds
  buffer_load_dwordx4 v7, s[16:19], s73 offen offset:2048 nt lds
  buffer_load_dwordx4 v8, s[16:19], s73 offen offset:3072 nt lds
  s_nop 7
  s_waitcnt vmcnt(32)
  v_mfma_f32_16x16x32_bf16 v[24:27], v[160:163], v[16:19], 0
  v_mfma_f32_16x16x32_bf16 v[24:27], v[164:167], v[20:23], v[24:27]
  v_mfma_f32_16x16x32_bf16 v[28:31], v[168:171], v[16:19], 0
  v_mfma_f32_16x16x32_bf16 v[28:31], v[172:175], v[20:23], v[28:31]
  v_mfma_f32_16x16x32_bf16 v[56:59], v[176:179], v[16:19], 0
  v_mfma_f32_16x16x32_bf16 v[56:59], v[180:183], v[20:23], v[56:59]
  v_mfma_f32_16x16x32_bf16 v[60:63], v[184:187], v[16:19], 0
  v_mfma_f32_16x16x32_bf16 v[60:63], v[188:191], v[20:23], v[60:63]
  s_nop 7
  s_nop 3
  v_permlane32_swap_b32 v24, v28
  v_permlane32_swap_b32 v25, v29
  v_permlane32_swap_b32 v26, v30
  v_permlane32_swap_b32 v27, v31
  v_permlane32_swap_b32 v56, v60
  v_permlane32_swap_b32 v57, v61
  v_permlane32_swap_b32 v58, v62
  v_permlane32_swap_b32 v59, v63
  s_nop 1
  v_add_f32_dpp v48, v28, v24 row_shl:4 row_mask:0xf bank_mask:0xf bound_ctrl:1
  v_add_f32_dpp v49, v29, v25 row_shl:4 row_mask:0xf bank_mask:0xf bound_ctrl:1
  v_add_f32_dpp v50, v30, v26 row_shl:4 row_mask:0xf bank_mask:0xf bound_ctrl:1
  v_add_f32_dpp v51, v31, v27 row_shl:4 row_mask:0xf bank_mask:0xf bound_ctrl:1
  v_add_f32_dpp v52, v60, v56 row_shl:4 row_mask:0xf bank_mask:0xf bound_ctrl:1
  v_add_f32_dpp v53, v61, v57 row_shl:4 row_mask:0xf bank_mask:0xf bound_ctrl:1
  v_add_f32_dpp v54, v62, v58 row_shl:4 row_mask:0xf bank_mask:0xf bound_ctrl:1
  v_add_f32_dpp v55, v63, v59 row_shl:4 row_mask:0xf bank_mask:0xf bound_ctrl:1
  v_cvt_pk_bf16_f32 v12, v48, v49
  v_lshlrev_b32 v48, 16, v12
  v_and_b32 v49, s42, v12
  v_mul_f32 v48, s41, v48
  v_mul_f32 v49, s41, v49
  v_cvt_pk_bf16_f32 v12, v48, v49
  v_lshlrev_b32 v48, 16, v12
  v_and_b32 v49, s42, v12
  v_cvt_pk_bf16_f32 v12, v50, v51
  v_lshlrev_b32 v50, 16, v12
  v_and_b32 v51, s42, v12
  v_mul_f32 v50, s41, v50
  v_mul_f32 v51, s41, v51
  v_cvt_pk_bf16_f32 v12, v50, v51
  v_lshlrev_b32 v50, 16, v12
  v_and_b32 v51, s42, v12
  v_cvt_pk_bf16_f32 v12, v52, v53
  v_lshlrev_b32 v52, 16, v12
  v_and_b32 v53, s42, v12
  v_mul_f32 v52, s41, v52
  v_mul_f32 v53, s41, v53
  v_cvt_pk_bf16_f32 v12, v52, v53
  v_lshlrev_b32 v52, 16, v12
  v_and_b32 v53, s42, v12
  v_cvt_pk_bf16_f32 v12, v54, v55
  v_lshlrev_b32 v54, 16, v12
  v_and_b32 v55, s42, v12
  v_mul_f32 v54, s41, v54
  v_mul_f32 v55, s41, v55
  v_cvt_pk_bf16_f32 v12, v54, v55
  v_lshlrev_b32 v54, 16, v12
  v_and_b32 v55, s42, v12
  v_max3_f32 v12, v48, v49, v50
  v_max3_f32 v12, v12, v51, v52
  v_max3_f32 v12, v12, v53, v54
  v_max_f32 v12, v12, v55
  v_mov_b32 v13, v12
  s_nop 1
  v_permlane32_swap_b32 v12, v13
  s_nop 1
  v_max_f32 v12, v12, v13
  v_mov_b32 v13, v12
  s_nop 1
  v_permlane16_swap_b32 v12, v13
  s_nop 1
  v_max_f32 v12, v12, v13
  v_max_f32 v12, v12, v10
  v_sub_f32 v14, v10, v12
  v_mul_f32 v14, s40, v14
  v_exp_f32 v14, v14
  v_mov_b32 v10, v12
  v_sub_f32 v48, v48, v10
  v_sub_f32 v49, v49, v10
  v_sub_f32 v50, v50, v10
  v_sub_f32 v51, v51, v10
  v_sub_f32 v52, v52, v10
  v_sub_f32 v53, v53, v10
  v_sub_f32 v54, v54, v10
  v_sub_f32 v55, v55, v10
  v_mul_f32 v48, s40, v48
  v_mul_f32 v49, s40, v49
  v_mul_f32 v50, s40, v50
  v_mul_f32 v51, s40, v51
  v_mul_f32 v52, s40, v52
  v_mul_f32 v53, s40, v53
  v_mul_f32 v54, s40, v54
  v_mul_f32 v55, s40, v55
  v_exp_f32 v48, v48
  v_exp_f32 v49, v49
  v_exp_f32 v50, v50
  v_exp_f32 v51, v51
  v_exp_f32 v52, v52
  v_exp_f32 v53, v53
  v_exp_f32 v54, v54
  v_exp_f32 v55, v55
  s_nop 0
  v_fma_f32 v11, v11, v14, v48
  v_mul_f32 v192, v192, v14
  v_mul_f32 v193, v193, v14
  v_mul_f32 v194, v194, v14
  v_mul_f32 v195, v195, v14
  v_mul_f32 v196, v196, v14
  v_mul_f32 v197, v197, v14
  v_mul_f32 v198, v198, v14
  v_mul_f32 v199, v199, v14
  v_mul_f32 v200, v200, v14
  v_mul_f32 v201, v201, v14
  v_mul_f32 v202, v202, v14
  v_mul_f32 v203, v203, v14
  v_mul_f32 v204, v204, v14
  v_mul_f32 v205, v205, v14
  v_mul_f32 v206, v206, v14
  v_mul_f32 v207, v207, v14
  v_mul_f32 v208, v208, v14
  v_mul_f32 v209, v209, v14
  v_mul_f32 v210, v210, v14
  v_mul_f32 v211, v211, v14
  v_mul_f32 v212, v212, v14
  v_mul_f32 v213, v213, v14
  v_mul_f32 v214, v214, v14
  v_mul_f32 v215, v215, v14
  v_mul_f32 v216, v216, v14
  v_mul_f32 v217, v217, v14
  v_mul_f32 v218, v218, v14
  v_mul_f32 v219, v219, v14
  v_mul_f32 v220, v220, v14
  v_mul_f32 v221, v221, v14
  v_mul_f32 v222, v222, v14
  v_mul_f32 v223, v223, v14
  v_add_f32 v11, v11, v49
  v_add_f32 v11, v11, v50
  v_add_f32 v11, v11, v51
  v_add_f32 v11, v11, v52
  v_add_f32 v11, v11, v53
  v_add_f32 v11, v11, v54
  v_add_f32 v11, v11, v55
  v_cvt_pk_bf16_f32 v32, v48, v49
  v_cvt_pk_bf16_f32 v33, v50, v51
  v_cvt_pk_bf16_f32 v34, v52, v53
  v_cvt_pk_bf16_f32 v35, v54, v55
  s_waitcnt vmcnt(8)
  ds_read_b64_tr_b16 v[48:49], v40 offset:8192
  ds_read_b64_tr_b16 v[50:51], v40 offset:12288
  ds_read_b64_tr_b16 v[52:53], v41 offset:8192
  ds_read_b64_tr_b16 v[54:55], v41 offset:12288
  ds_read_b64_tr_b16 v[56:57], v42 offset:8192
  ds_read_b64_tr_b16 v[58:59], v42 offset:12288
  ds_read_b64_tr_b16 v[60:61], v43 offset:8192
  ds_read_b64_tr_b16 v[62:63], v43 offset:12288
  s_waitcnt lgkmcnt(6)
  v_mfma_f32_16x16x32_bf16 v[192:195], v[48:51], v[32:35], v[192:195]
  s_waitcnt lgkmcnt(4)
  v_mfma_f32_16x16x32_bf16 v[196:199], v[52:55], v[32:35], v[196:199]
  s_waitcnt lgkmcnt(2)
  v_mfma_f32_16x16x32_bf16 v[200:203], v[56:59], v[32:35], v[200:203]
  s_waitcnt lgkmcnt(0)
  v_mfma_f32_16x16x32_bf16 v[204:207], v[60:63], v[32:35], v[204:207]
  s_nop 7
  ds_read_b64_tr_b16 v[48:49], v44 offset:8192
  ds_read_b64_tr_b16 v[50:51], v44 offset:12288
  ds_read_b64_tr_b16 v[52:53], v45 offset:8192
  ds_read_b64_tr_b16 v[54:55], v45 offset:12288
  ds_read_b64_tr_b16 v[56:57], v46 offset:8192
  ds_read_b64_tr_b16 v[58:59], v46 offset:12288
  ds_read_b64_tr_b16 v[60:61], v47 offset:8192
  ds_read_b64_tr_b16 v[62:63], v47 offset:12288
  s_waitcnt lgkmcnt(6)
  v_mfma_f32_16x16x32_bf16 v[208:211], v[48:51], v[32:35], v[208:211]
  s_waitcnt lgkmcnt(4)
  v_mfma_f32_16x16x32_bf16 v[212:215], v[52:55], v[32:35], v[212:215]
  s_waitcnt lgkmcnt(2)
  v_mfma_f32_16x16x32_bf16 v[216:219], v[56:59], v[32:35], v[216:219]
  s_waitcnt lgkmcnt(0)
  v_mfma_f32_16x16x32_bf16 v[220:223], v[60:63], v[32:35], v[220:223]
  s_nop 7
  s_cmp_le_u32 s22, 4
  s_cbranch_scc1 F_LOOPD
  s_waitcnt vmcnt(24)
  v_mfma_f32_16x16x32_bf16 v[24:27], v[64:67], v[16:19], 0
  v_mfma_f32_16x16x32_bf16 v[24:27], v[68:71], v[20:23], v[24:27]
  v_mfma_f32_16x16x32_bf16 v[28:31], v[72:75], v[16:19], 0
  v_mfma_f32_16x16x32_bf16 v[28:31], v[76:79], v[20:23], v[28:31]
  v_mfma_f32_16x16x32_bf16 v[56:59], v[80:83], v[16:19], 0
  v_mfma_f32_16x16x32_bf16 v[56:59], v[84:87], v[20:23], v[56:59]
  v_mfma_f32_16x16x32_bf16 v[60:63], v[88:91], v[16:19], 0
  v_mfma_f32_16x16x32_bf16 v[60:63], v[92:95], v[20:23], v[60:63]
  s_nop 7
  s_nop 3
  v_permlane32_swap_b32 v24, v28
  v_permlane32_swap_b32 v25, v29
  v_permlane32_swap_b32 v26, v30
  v_permlane32_swap_b32 v27, v31
  v_permlane32_swap_b32 v56, v60
  v_permlane32_swap_b32 v57, v61
  v_permlane32_swap_b32 v58, v62
  v_permlane32_swap_b32 v59, v63
  s_nop 1
  v_add_f32_dpp v48, v28, v24 row_shl:4 row_mask:0xf bank_mask:0xf bound_ctrl:1
  v_add_f32_dpp v49, v29, v25 row_shl:4 row_mask:0xf bank_mask:0xf bound_ctrl:1
  v_add_f32_dpp v50, v30, v26 row_shl:4 row_mask:0xf bank_mask:0xf bound_ctrl:1
  v_add_f32_dpp v51, v31, v27 row_shl:4 row_mask:0xf bank_mask:0xf bound_ctrl:1
  v_add_f32_dpp v52, v60, v56 row_shl:4 row_mask:0xf bank_mask:0xf bound_ctrl:1
  v_add_f32_dpp v53, v61, v57 row_shl:4 row_mask:0xf bank_mask:0xf bound_ctrl:1
  v_add_f32_dpp v54, v62, v58 row_shl:4 row_mask:0xf bank_mask:0xf bound_ctrl:1
  v_add_f32_dpp v55, v63, v59 row_shl:4 row_mask:0xf bank_mask:0xf bound_ctrl:1
  v_cvt_pk_bf16_f32 v12, v48, v49
  v_lshlrev_b32 v48, 16, v12
  v_and_b32 v49, s42, v12
  v_mul_f32 v48, s41, v48
  v_mul_f32 v49, s41, v49
  v_cvt_pk_bf16_f32 v12, v48, v49
  v_lshlrev_b32 v48, 16, v12
  v_and_b32 v49, s42, v12
  v_cvt_pk_bf16_f32 v12, v50, v51
  v_lshlrev_b32 v50, 16, v12
  v_and_b32 v51, s42, v12
  v_mul_f32 v50, s41, v50
  v_mul_f32 v51, s41, v51
  v_cvt_pk_bf16_f32 v12, v50, v51
  v_lshlrev_b32 v50, 16, v12
  v_and_b32 v51, s42, v12
  v_cvt_pk_bf16_f32 v12, v52, v53
  v_lshlrev_b32 v52, 16, v12
  v_and_b32 v53, s42, v12
  v_mul_f32 v52, s41, v52
  v_mul_f32 v53, s41, v53
  v_cvt_pk_bf16_f32 v12, v52, v53
  v_lshlrev_b32 v52, 16, v12
  v_and_b32 v53, s42, v12
  v_cvt_pk_bf16_f32 v12, v54, v55
  v_lshlrev_b32 v54, 16, v12
  v_and_b32 v55, s42, v12
  v_mul_f32 v54, s41, v54
  v_mul_f32 v55, s41, v55
  v_cvt_pk_bf16_f32 v12, v54, v55
  v_lshlrev_b32 v54, 16, v12
  v_and_b32 v55, s42, v12
  v_max3_f32 v12, v48, v49, v50
  v_max3_f32 v12, v12, v51, v52
  v_max3_f32 v12, v12, v53, v54
  v_max_f32 v12, v12, v55
  v_mov_b32 v13, v12
  s_nop 1
  v_permlane32_swap_b32 v12, v13
  s_nop 1
  v_max_f32 v12, v12, v13
  v_mov_b32 v13, v12
  s_nop 1
  v_permlane16_swap_b32 v12, v13
  s_nop 1
  v_max_f32 v12, v12, v13
  v_max_f32 v12, v12, v10
  v_sub_f32 v14, v10, v12
  v_mul_f32 v14, s40, v14
  v_exp_f32 v14, v14
  v_mov_b32 v10, v12
  v_sub_f32 v48, v48, v10
  v_sub_f32 v49, v49, v10
  v_sub_f32 v50, v50, v10
  v_sub_f32 v51, v51, v10
  v_sub_f32 v52, v52, v10
  v_sub_f32 v53, v53, v10
  v_sub_f32 v54, v54, v10
  v_sub_f32 v55, v55, v10
  v_mul_f32 v48, s40, v48
  v_mul_f32 v49, s40, v49
  v_mul_f32 v50, s40, v50
  v_mul_f32 v51, s40, v51
  v_mul_f32 v52, s40, v52
  v_mul_f32 v53, s40, v53
  v_mul_f32 v54, s40, v54
  v_mul_f32 v55, s40, v55
  v_exp_f32 v48, v48
  v_exp_f32 v49, v49
  v_exp_f32 v50, v50
  v_exp_f32 v51, v51
  v_exp_f32 v52, v52
  v_exp_f32 v53, v53
  v_exp_f32 v54, v54
  v_exp_f32 v55, v55
  s_nop 0
  v_fma_f32 v11, v11, v14, v48
  v_mul_f32 v192, v192, v14
  v_mul_f32 v193, v193, v14
  v_mul_f32 v194, v194, v14
  v_mul_f32 v195, v195, v14
  v_mul_f32 v196, v196, v14
  v_mul_f32 v197, v197, v14
  v_mul_f32 v198, v198, v14
  v_mul_f32 v199, v199, v14
  v_mul_f32 v200, v200, v14
  v_mul_f32 v201, v201, v14
  v_mul_f32 v202, v202, v14
  v_mul_f32 v203, v203, v14
  v_mul_f32 v204, v204, v14
  v_mul_f32 v205, v205, v14
  v_mul_f32 v206, v206, v14
  v_mul_f32 v207, v207, v14
  v_mul_f32 v208, v208, v14
  v_mul_f32 v209, v209, v14
  v_mul_f32 v210, v210, v14
  v_mul_f32 v211, v211, v14
  v_mul_f32 v212, v212, v14
  v_mul_f32 v213, v213, v14
  v_mul_f32 v214, v214, v14
  v_mul_f32 v215, v215, v14
  v_mul_f32 v216, v216, v14
  v_mul_f32 v217, v217, v14
  v_mul_f32 v218, v218, v14
  v_mul_f32 v219, v219, v14
  v_mul_f32 v220, v220, v14
  v_mul_f32 v221, v221, v14
  v_mul_f32 v222, v222, v14
  v_mul_f32 v223, v223, v14
  v_add_f32 v11, v11, v49
  v_add_f32 v11, v11, v50
  v_add_f32 v11, v11, v51
  v_add_f32 v11, v11, v52
  v_add_f32 v11, v11, v53
  v_add_f32 v11, v11, v54
  v_add_f32 v11, v11, v55
  v_cvt_pk_bf16_f32 v32, v48, v49
  v_cvt_pk_bf16_f32 v33, v50, v51
  v_cvt_pk_bf16_f32 v34, v52, v53
  v_cvt_pk_bf16_f32 v35, v54, v55
  s_waitcnt vmcnt(0)
  ds_read_b64_tr_b16 v[48:49], v40 offset:0
  ds_read_b64_tr_b16 v[50:51], v40 offset:4096
  ds_read_b64_tr_b16 v[52:53], v41 offset:0
  ds_read_b64_tr_b16 v[54:55], v41 offset:4096
  ds_read_b64_tr_b16 v[56:57], v42 offset:0
  ds_read_b64_tr_b16 v[58:59], v42 offset:4096
  ds_read_b64_tr_b16 v[60:61], v43 offset:0
  ds_read_b64_tr_b16 v[62:63], v43 offset:4096
  s_waitcnt lgkmcnt(6)
  v_mfma_f32_16x16x32_bf16 v[192:195], v[48:51], v[32:35], v[192:195]
  s_waitcnt lgkmcnt(4)
  v_mfma_f32_16x16x32_bf16 v[196:199], v[52:55], v[32:35], v[196:199]
  s_waitcnt lgkmcnt(2)
  v_mfma_f32_16x16x32_bf16 v[200:203], v[56:59], v[32:35], v[200:203]
  s_waitcnt lgkmcnt(0)
  v_mfma_f32_16x16x32_bf16 v[204:207], v[60:63], v[32:35], v[204:207]
  s_nop 7
  ds_read_b64_tr_b16 v[48:49], v44 offset:0
  ds_read_b64_tr_b16 v[50:51], v44 offset:4096
  ds_read_b64_tr_b16 v[52:53], v45 offset:0
  ds_read_b64_tr_b16 v[54:55], v45 offset:4096
  ds_read_b64_tr_b16 v[56:57], v46 offset:0
  ds_read_b64_tr_b16 v[58:59], v46 offset:4096
  ds_read_b64_tr_b16 v[60:61], v47 offset:0
  ds_read_b64_tr_b16 v[62:63], v47 offset:4096
  s_waitcnt lgkmcnt(6)
  v_mfma_f32_16x16x32_bf16 v[208:211], v[48:51], v[32:35], v[208:211]
  s_waitcnt lgkmcnt(4)
  v_mfma_f32_16x16x32_bf16 v[212:215], v[52:55], v[32:35], v[212:215]
  s_waitcnt lgkmcnt(2)
  v_mfma_f32_16x16x32_bf16 v[216:219], v[56:59], v[32:35], v[216:219]
  s_waitcnt lgkmcnt(0)
  v_mfma_f32_16x16x32_bf16 v[220:223], v[60:63], v[32:35], v[220:223]
  s_nop 7
F_LOOPD:
  s_waitcnt vmcnt(0)
  s_nop 3
  v_mov_b32 v13, v11
  s_nop 1
  v_permlane32_swap_b32 v11, v13
  s_nop 1
  v_add_f32 v11, v11, v13
  v_mov_b32 v13, v11
  s_nop 1
  v_permlane16_swap_b32 v11, v13
  s_nop 1
  v_add_f32 v11, v11, v13
  v_lshlrev_b32 v5, 9, v4
  v_lshl_add_u32 v5, v3, 4, v5
  v_add_u32 v5, s23, v5
  v_lshlrev_b32 v6, 3, v4
  v_add_u32 v6, s23, v6
  v_cmp_gt_u32 vcc, 4, v4
  s_and_saveexec_b64 s[36:37], vcc
  ds_write_b128 v5, v[192:195] offset:0
  ds_write_b128 v5, v[196:199] offset:64
  ds_write_b128 v5, v[200:203] offset:128
  ds_write_b128 v5, v[204:207] offset:192
  ds_write_b128 v5, v[208:211] offset:256
  ds_write_b128 v5, v[212:215] offset:320
  ds_write_b128 v5, v[216:219] offset:384
  ds_write_b128 v5, v[220:223] offset:448
  ds_write_b64 v6, v[10:11] offset:2048
  s_mov_b64 exec, s[36:37]
  s_waitcnt lgkmcnt(0)
F_MERGE:
  s_barrier
  v_lshrrev_b32 v5, 7, v0
  v_lshlrev_b32 v5, 3, v5
  v_lshlrev_b32 v6, 2, v0
  v_add_u32 v7, 0x10000, v5
  v_add_u32 v8, 0x10000, v6
  ds_read_b64 v[16:17], v5 offset:2048
  ds_read_b32 v32, v6 offset:0
  ds_read_b64 v[18:19], v5 offset:18432
  ds_read_b32 v33, v6 offset:16384
  ds_read_b64 v[20:21], v5 offset:34816
  ds_read_b32 v34, v6 offset:32768
  ds_read_b64 v[22:23], v5 offset:51200
  ds_read_b32 v35, v6 offset:49152
  ds_read_b64 v[24:25], v7 offset:2048
  ds_read_b32 v36, v8 offset:0
  ds_read_b64 v[26:27], v7 offset:18432
  ds_read_b32 v37, v8 offset:16384
  ds_read_b64 v[28:29], v7 offset:34816
  ds_read_b32 v38, v8 offset:32768
  s_waitcnt lgkmcnt(0)
  v_max3_f32 v10, v16, v18, v20
  v_max3_f32 v10, v10, v22, v24
  v_max3_f32 v10, v10, v26, v28
  v_sub_f32 v16, v16, v10
  v_mul_f32 v16, s40, v16
  v_exp_f32 v16, v16
  v_sub_f32 v18, v18, v10
  v_mul_f32 v18, s40, v18
  v_exp_f32 v18, v18
  v_sub_f32 v20, v20, v10
  v_mul_f32 v20, s40, v20
  v_exp_f32 v20, v20
  v_sub_f32 v22, v22, v10
  v_mul_f32 v22, s40, v22
  v_exp_f32 v22, v22
  v_sub_f32 v24, v24, v10
  v_mul_f32 v24, s40, v24
  v_exp_f32 v24, v24
  v_sub_f32 v26, v26, v10
  v_mul_f32 v26, s40, v26
  v_exp_f32 v26, v26
  v_sub_f32 v28, v28, v10
  v_mul_f32 v28, s40, v28
  v_exp_f32 v28, v28
  s_nop 0
  v_mul_f32 v11, v16, v17
  v_mul_f32 v12, v16, v32
  v_fma_f32 v11, v18, v19, v11
  v_fma_f32 v12, v18, v33, v12
  v_fma_f32 v11, v20, v21, v11
  v_fma_f32 v12, v20, v34, v12
  v_fma_f32 v11, v22, v23, v11
  v_fma_f32 v12, v22, v35, v12
  v_fma_f32 v11, v24, v25, v11
  v_fma_f32 v12, v24, v36, v12
  v_fma_f32 v11, v26, v27, v11
  v_fma_f32 v12, v26, v37, v12
  v_fma_f32 v11, v28, v29, v11
  v_fma_f32 v12, v28, v38, v12
  s_lshl_b32 s34, s2, 12
  s_add_u32 s34, s34, 1048576
  buffer_store_dword v12, v6, s[24:27], s34 offen
  v_and_b32 v7, 127, v0
  v_cmp_eq_u32 vcc, 0, v7
  s_and_saveexec_b64 s[36:37], vcc
  buffer_store_dwordx2 v[10:11], v5, s[24:27], s34 offen offset:2048
  s_mov_b64 exec, s[36:37]
  s_endpgm
F_AUX:
  s_mov_b32 s28, s50
  s_and_b32 s29, s51, 0xffff
  s_mov_b32 s30, 4096
  s_mov_b32 s31, 0x00020000
  s_mov_b32 s80, s8
  s_and_b32 s81, s9, 0xffff
  s_mov_b32 s82, 256
  s_mov_b32 s83, 0x00020000
  s_mov_b32 s44, s52
  s_and_b32 s45, s53, 0xffff
  s_mov_b32 s46, 4194304
  s_mov_b32 s47, 0x00020000
  s_movk_i32 s34, 0x2000
  s_mov_b32 s36, 0x4000
  s_and_b32 s35, s2, 63
  s_lshl_b32 s37, s32, 20
  s_lshl_b32 s38, s35, 7
  s_add_u32 s37, s37, s38
  s_lshl_b32 s39, s32, 8
  s_lshl_b32 s40, s32, 16
  s_lshl_b32 s38, s35, 8
  s_add_u32 s40, s40, s38
  s_add_u32 s40, s40, 0
  v_lshrrev_b32 v6, 3, v2
  v_and_b32 v7, 7, v2
  v_and_b32 v5, 3, v2
  v_mul_lo_u32 v8, v6, s34
  v_lshl_add_u32 v8, v7, 4, v8
  s_lshl_b32 s38, s34, 3
  buffer_load_dwordx4 v[32:35], v8, s[44:47], s37 offen nt
  s_add_u32 s37, s37, s38
  buffer_load_dwordx4 v[36:39], v8, s[44:47], s37 offen nt
  s_add_u32 s37, s37, s38
  buffer_load_dwordx4 v[40:43], v8, s[44:47], s37 offen nt
  s_add_u32 s37, s37, s38
  buffer_load_dwordx4 v[44:47], v8, s[44:47], s37 offen nt
  s_add_u32 s37, s37, s38
  buffer_load_dwordx4 v[48:51], v8, s[44:47], s37 offen nt
  s_add_u32 s37, s37, s38
  buffer_load_dwordx4 v[52:55], v8, s[44:47], s37 offen nt
  s_add_u32 s37, s37, s38
  buffer_load_dwordx4 v[56:59], v8, s[44:47], s37 offen nt
  s_add_u32 s37, s37, s38
  buffer_load_dwordx4 v[60:63], v8, s[44:47], s37 offen nt
  s_add_u32 s37, s37, s38
  buffer_load_dwordx4 v[64:67], v8, s[44:47], s37 offen nt
  s_add_u32 s37, s37, s38
  buffer_load_dwordx4 v[68:71], v8, s[44:47], s37 offen nt
  s_add_u32 s37, s37, s38
  buffer_load_dwordx4 v[72:75], v8, s[44:47], s37 offen nt
  s_add_u32 s37, s37, s38
  buffer_load_dwordx4 v[76:79], v8, s[44:47], s37 offen nt
  s_add_u32 s37, s37, s38
  buffer_load_dwordx4 v[80:83], v8, s[44:47], s37 offen nt
  s_add_u32 s37, s37, s38
  buffer_load_dwordx4 v[84:87], v8, s[44:47], s37 offen nt
  s_add_u32 s37, s37, s38
  buffer_load_dwordx4 v[88:91], v8, s[44:47], s37 offen nt
  s_add_u32 s37, s37, s38
  buffer_load_dwordx4 v[92:95], v8, s[44:47], s37 offen nt
  v_lshlrev_b32 v9, 10, v5
  v_lshl_add_u32 v9, v3, 4, v9
  buffer_load_dwordx4 v[16:19], v9, s[28:31], s39 offen offset:0
  buffer_load_dwordx4 v[20:23], v9, s[28:31], s39 offen offset:64
  buffer_load_dwordx4 v[24:27], v9, s[28:31], s39 offen offset:128
  buffer_load_dwordx4 v[28:31], v9, s[28:31], s39 offen offset:192
  s_min_u32 s87, s2, 223
  s_and_b32 s48, s87, 3
  s_lshr_b32 s35, s87, 2
  s_mov_b32 s88, 262144
  s_mov_b32 s76, s56
  s_mov_b32 s77, s57
  s_cmp_lt_u32 s35, 28
  s_cbranch_scc1 F_G
  s_sub_u32 s35, s35, 28
  s_mov_b32 s88, 393216
  s_mov_b32 s76, s58
  s_mov_b32 s77, s59
F_G:
  s_and_b32 s77, s77, 0xffff
  s_mov_b32 s78, 1835008
  s_mov_b32 s79, 0x00020000
  s_movk_i32 s34, 3584
  s_movk_i32 s89, 7168
  s_mul_i32 s37, s48, 458752
  s_lshl_b32 s38, s35, 7
  s_add_u32 s37, s37, s38
  s_lshl_b32 s39, s48, 8
  s_mul_i32 s38, s48, 28672
  s_add_u32 s88, s88, s38
  s_lshl_b32 s38, s35, 8
  s_add_u32 s88, s88, s38
  s_cmp_ge_u32 s2, 224
  s_cbranch_scc1 F_NOGU
  v_lshrrev_b32 v6, 3, v2
  v_and_b32 v7, 7, v2
  v_and_b32 v5, 3, v2
  v_mul_lo_u32 v8, v6, s34
  v_lshl_add_u32 v8, v7, 4, v8
  s_lshl_b32 s38, s34, 3
  buffer_load_dwordx4 v[128:131], v8, s[76:79], s37 offen nt
  s_add_u32 s37, s37, s38
  buffer_load_dwordx4 v[132:135], v8, s[76:79], s37 offen nt
  s_add_u32 s37, s37, s38
  buffer_load_dwordx4 v[136:139], v8, s[76:79], s37 offen nt
  s_add_u32 s37, s37, s38
  buffer_load_dwordx4 v[140:143], v8, s[76:79], s37 offen nt
  s_add_u32 s37, s37, s38
  buffer_load_dwordx4 v[144:147], v8, s[76:79], s37 offen nt
  s_add_u32 s37, s37, s38
  buffer_load_dwordx4 v[148:151], v8, s[76:79], s37 offen nt
  s_add_u32 s37, s37, s38
  buffer_load_dwordx4 v[152:155], v8, s[76:79], s37 offen nt
  s_add_u32 s37, s37, s38
  buffer_load_dwordx4 v[156:159], v8, s[76:79], s37 offen nt
  s_add_u32 s37, s37, s38
  buffer_load_dwordx4 v[160:163], v8, s[76:79], s37 offen nt
  s_add_u32 s37, s37, s38
  buffer_load_dwordx4 v[164:167], v8, s[76:79], s37 offen nt
  s_add_u32 s37, s37, s38
  buffer_load_dwordx4 v[168:171], v8, s[76:79], s37 offen nt
  s_add_u32 s37, s37, s38
  buffer_load_dwordx4 v[172:175], v8, s[76:79], s37 offen nt
  s_add_u32 s37, s37, s38
  buffer_load_dwordx4 v[176:179], v8, s[76:79], s37 offen nt
  s_add_u32 s37, s37, s38
  buffer_load_dwordx4 v[180:183], v8, s[76:79], s37 offen nt
  s_add_u32 s37, s37, s38
  buffer_load_dwordx4 v[184:187], v8, s[76:79], s37 offen nt
  s_add_u32 s37, s37, s38
  buffer_load_dwordx4 v[188:191], v8, s[76:79], s37 offen nt
  v_lshlrev_b32 v9, 10, v5
  v_lshl_add_u32 v9, v3, 4, v9
  buffer_load_dwordx4 v[112:115], v9, s[28:31], s39 offen offset:0
  buffer_load_dwordx4 v[116:119], v9, s[28:31], s39 offen offset:64
  buffer_load_dwordx4 v[120:123], v9, s[28:31], s39 offen offset:128
  buffer_load_dwordx4 v[124:127], v9, s[28:31], s39 offen offset:192
  s_barrier
  s_waitcnt vmcnt(20)
  s_branch F_QC
F_NOGU:
  s_barrier
  s_waitcnt vmcnt(0)
F_QC:
  v_lshlrev_b32 v10, 4, v2
  v_add_u32 v10, s23, v10
  v_lshrrev_b32 v11, 2, v4
  v_lshl_add_u32 v11, v3, 3, v11
  v_lshlrev_b32 v11, 7, v11
  v_lshl_add_u32 v11, v5, 3, v11
  v_add_u32 v11, s23, v11
  ds_write_b128 v10, v[32:35] offset:0
  ds_write_b128 v10, v[36:39] offset:1024
  ds_write_b128 v10, v[40:43] offset:2048
  ds_write_b128 v10, v[44:47] offset:3072
  ds_write_b128 v10, v[48:51] offset:4096
  ds_write_b128 v10, v[52:55] offset:5120
  ds_write_b128 v10, v[56:59] offset:6144
  ds_write_b128 v10, v[60:63] offset:7168
  ds_write_b128 v10, v[64:67] offset:8192
  ds_write_b128 v10, v[68:71] offset:9216
  ds_write_b128 v10, v[72:75] offset:10240
  ds_write_b128 v10, v[76:79] offset:11264
  ds_write_b128 v10, v[80:83] offset:12288
  ds_write_b128 v10, v[84:87] offset:13312
  ds_write_b128 v10, v[88:91] offset:14336
  ds_write_b128 v10, v[92:95] offset:15360
  s_waitcnt lgkmcnt(0)
  ds_read_b64_tr_b16 v[32:33], v11 offset:0
  ds_read_b64_tr_b16 v[34:35], v11 offset:512
  ds_read_b64_tr_b16 v[36:37], v11 offset:4096
  ds_read_b64_tr_b16 v[38:39], v11 offset:4608
  ds_read_b64_tr_b16 v[40:41], v11 offset:8192
  ds_read_b64_tr_b16 v[42:43], v11 offset:8704
  ds_read_b64_tr_b16 v[44:45], v11 offset:12288
  ds_read_b64_tr_b16 v[46:47], v11 offset:12800
  ds_read_b64_tr_b16 v[48:49], v11 offset:32
  ds_read_b64_tr_b16 v[50:51], v11 offset:544
  ds_read_b64_tr_b16 v[52:53], v11 offset:4128
  ds_read_b64_tr_b16 v[54:55], v11 offset:4640
  ds_read_b64_tr_b16 v[56:57], v11 offset:8224
  ds_read_b64_tr_b16 v[58:59], v11 offset:8736
  ds_read_b64_tr_b16 v[60:61], v11 offset:12320
  ds_read_b64_tr_b16 v[62:63], v11 offset:12832
  ds_read_b64_tr_b16 v[64:65], v11 offset:64
  ds_read_b64_tr_b16 v[66:67], v11 offset:576
  ds_read_b64_tr_b16 v[68:69], v11 offset:4160
  ds_read_b64_tr_b16 v[70:71], v11 offset:4672
  ds_read_b64_tr_b16 v[72:73], v11 offset:8256
  ds_read_b64_tr_b16 v[74:75], v11 offset:8768
  ds_read_b64_tr_b16 v[76:77], v11 offset:12352
  ds_read_b64_tr_b16 v[78:79], v11 offset:12864
  ds_read_b64_tr_b16 v[80:81], v11 offset:96
  ds_read_b64_tr_b16 v[82:83], v11 offset:608
  ds_read_b64_tr_b16 v[84:85], v11 offset:4192
  ds_read_b64_tr_b16 v[86:87], v11 offset:4704
  ds_read_b64_tr_b16 v[88:89], v11 offset:8288
  ds_read_b64_tr_b16 v[90:91], v11 offset:8800
  ds_read_b64_tr_b16 v[92:93], v11 offset:12384
  ds_read_b64_tr_b16 v[94:95], v11 offset:12896
  s_waitcnt lgkmcnt(0)
  v_mfma_f32_16x16x32_bf16 v[96:99], v[32:35], v[16:19], 0
  v_mfma_f32_16x16x32_bf16 v[96:99], v[36:39], v[20:23], v[96:99]
  v_mfma_f32_16x16x32_bf16 v[96:99], v[40:43], v[24:27], v[96:99]
  v_mfma_f32_16x16x32_bf16 v[96:99], v[44:47], v[28:31], v[96:99]
  v_mfma_f32_16x16x32_bf16 v[100:103], v[48:51], v[16:19], 0
  v_mfma_f32_16x16x32_bf16 v[100:103], v[52:55], v[20:23], v[100:103]
  v_mfma_f32_16x16x32_bf16 v[100:103], v[56:59], v[24:27], v[100:103]
  v_mfma_f32_16x16x32_bf16 v[100:103], v[60:63], v[28:31], v[100:103]
  v_mfma_f32_16x16x32_bf16 v[104:107], v[64:67], v[16:19], 0
  v_mfma_f32_16x16x32_bf16 v[104:107], v[68:71], v[20:23], v[104:107]
  v_mfma_f32_16x16x32_bf16 v[104:107], v[72:75], v[24:27], v[104:107]
  v_mfma_f32_16x16x32_bf16 v[104:107], v[76:79], v[28:31], v[104:107]
  v_mfma_f32_16x16x32_bf16 v[108:111], v[80:83], v[16:19], 0
  v_mfma_f32_16x16x32_bf16 v[108:111], v[84:87], v[20:23], v[108:111]
  v_mfma_f32_16x16x32_bf16 v[108:111], v[88:91], v[24:27], v[108:111]
  v_mfma_f32_16x16x32_bf16 v[108:111], v[92:95], v[28:31], v[108:111]
  v_mul_lo_u32 v12, v4, s36
  v_lshl_add_u32 v12, v3, 4, v12
  v_cmp_gt_u32 vcc, 4, v4
  s_and_saveexec_b64 s[42:43], vcc
  s_nop 7
  buffer_store_dwordx4 v[96:99], v12, s[24:27], s40 offen offset:0 sc1
  buffer_store_dwordx4 v[100:103], v12, s[24:27], s40 offen offset:64 sc1
  buffer_store_dwordx4 v[104:107], v12, s[24:27], s40 offen offset:128 sc1
  buffer_store_dwordx4 v[108:111], v12, s[24:27], s40 offen offset:192 sc1
  s_mov_b64 exec, s[42:43]
  s_waitcnt vmcnt(0)
  s_lshl_b32 s49, s33, 5
  v_mov_b32 v14, 0
  v_mov_b32 v28, 1
  v_cmp_eq_u32 vcc, 0, v2
  s_and_saveexec_b64 s[42:43], vcc
  buffer_atomic_add v28, v14, s[80:83], s49 offen sc0 sc1
  s_waitcnt vmcnt(0)
  v_readfirstlane_b32 s54, v28
  s_add_u32 s54, s54, 1
  s_cmp_ge_u32 s54, 32
  s_cbranch_scc1 F_GOTQ
  s_mov_b32 s55, 200000
F_POLL:
  s_sleep 8
  buffer_load_dword v15, v14, s[80:83], s49 offen sc1
  s_waitcnt vmcnt(0)
  v_readfirstlane_b32 s54, v15
  s_sub_u32 s55, s55, 1
  s_cmp_eq_u32 s55, 0
  s_cbranch_scc1 F_GOTQ
  s_cmp_lt_u32 s54, 32
  s_cbranch_scc1 F_POLL
F_GOTQ:
  s_mov_b64 exec, s[42:43]
  s_lshl_b32 s49, s32, 14
  s_lshl_b32 s54, s33, 11
  s_add_u32 s49, s49, s54
  v_lshlrev_b32 v14, 5, v2
  s_add_u32 s54, s49, 0
  buffer_load_dwordx4 v[16:19], v14, s[24:27], s54 offen sc1
  buffer_load_dwordx4 v[20:23], v14, s[24:27], s54 offen offset:16 sc1
  s_add_u32 s54, s49, 65536
  buffer_load_dwordx4 v[24:27], v14, s[24:27], s54 offen sc1
  buffer_load_dwordx4 v[28:31], v14, s[24:27], s54 offen offset:16 sc1
  s_add_u32 s54, s49, 131072
  buffer_load_dwordx4 v[32:35], v14, s[24:27], s54 offen sc1
  buffer_load_dwordx4 v[36:39], v14, s[24:27], s54 offen offset:16 sc1
  s_add_u32 s54, s49, 196608
  buffer_load_dwordx4 v[40:43], v14, s[24:27], s54 offen sc1
  buffer_load_dwordx4 v[44:47], v14, s[24:27], s54 offen offset:16 sc1
  v_lshlrev_b32 v14, 4, v2
  v_add_u32 v14, 131072, v14
  s_waitcnt vmcnt(0)
  v_add_f32 v16, v16, v24
  v_add_f32 v32, v32, v40
  v_add_f32 v17, v17, v25
  v_add_f32 v33, v33, v41
  v_add_f32 v18, v18, v26
  v_add_f32 v34, v34, v42
  v_add_f32 v19, v19, v27
  v_add_f32 v35, v35, v43
  v_add_f32 v20, v20, v28
  v_add_f32 v36, v36, v44
  v_add_f32 v21, v21, v29
  v_add_f32 v37, v37, v45
  v_add_f32 v22, v22, v30
  v_add_f32 v38, v38, v46
  v_add_f32 v23, v23, v31
  v_add_f32 v39, v39, v47
  v_add_f32 v16, v16, v32
  v_add_f32 v17, v17, v33
  v_add_f32 v18, v18, v34
  v_add_f32 v19, v19, v35
  v_add_f32 v20, v20, v36
  v_add_f32 v21, v21, v37
  v_add_f32 v22, v22, v38
  v_add_f32 v23, v23, v39
  v_cvt_pk_bf16_f32 v16, v16, v17
  v_cvt_pk_bf16_f32 v17, v18, v19
  v_cvt_pk_bf16_f32 v18, v20, v21
  v_cvt_pk_bf16_f32 v19, v22, v23
  ds_write_b128 v14, v[16:19]
  s_waitcnt lgkmcnt(0)
  s_barrier
  s_cmp_ge_u32 s2, 224
  s_cbranch_scc1 F_AD
  v_lshlrev_b32 v10, 4, v2
  v_add_u32 v10, s23, v10
  v_lshrrev_b32 v11, 2, v4
  v_lshl_add_u32 v11, v3, 3, v11
  v_lshlrev_b32 v11, 7, v11
  v_lshl_add_u32 v11, v5, 3, v11
  v_add_u32 v11, s23, v11
  ds_write_b128 v10, v[128:131] offset:0
  ds_write_b128 v10, v[132:135] offset:1024
  ds_write_b128 v10, v[136:139] offset:2048
  ds_write_b128 v10, v[140:143] offset:3072
  ds_write_b128 v10, v[144:147] offset:4096
  ds_write_b128 v10, v[148:151] offset:5120
  ds_write_b128 v10, v[152:155] offset:6144
  ds_write_b128 v10, v[156:159] offset:7168
  ds_write_b128 v10, v[160:163] offset:8192
  ds_write_b128 v10, v[164:167] offset:9216
  ds_write_b128 v10, v[168:171] offset:10240
  ds_write_b128 v10, v[172:175] offset:11264
  ds_write_b128 v10, v[176:179] offset:12288
  ds_write_b128 v10, v[180:183] offset:13312
  ds_write_b128 v10, v[184:187] offset:14336
  ds_write_b128 v10, v[188:191] offset:15360
  s_waitcnt lgkmcnt(0)
  ds_read_b64_tr_b16 v[128:129], v11 offset:0
  ds_read_b64_tr_b16 v[130:131], v11 offset:512
  ds_read_b64_tr_b16 v[132:133], v11 offset:4096
  ds_read_b64_tr_b16 v[134:135], v11 offset:4608
  ds_read_b64_tr_b16 v[136:137], v11 offset:8192
  ds_read_b64_tr_b16 v[138:139], v11 offset:8704
  ds_read_b64_tr_b16 v[140:141], v11 offset:12288
  ds_read_b64_tr_b16 v[142:143], v11 offset:12800
  ds_read_b64_tr_b16 v[144:145], v11 offset:32
  ds_read_b64_tr_b16 v[146:147], v11 offset:544
  ds_read_b64_tr_b16 v[148:149], v11 offset:4128
  ds_read_b64_tr_b16 v[150:151], v11 offset:4640
  ds_read_b64_tr_b16 v[152:153], v11 offset:8224
  ds_read_b64_tr_b16 v[154:155], v11 offset:8736
  ds_read_b64_tr_b16 v[156:157], v11 offset:12320
  ds_read_b64_tr_b16 v[158:159], v11 offset:12832
  ds_read_b64_tr_b16 v[160:161], v11 offset:64
  ds_read_b64_tr_b16 v[162:163], v11 offset:576
  ds_read_b64_tr_b16 v[164:165], v11 offset:4160
  ds_read_b64_tr_b16 v[166:167], v11 offset:4672
  ds_read_b64_tr_b16 v[168:169], v11 offset:8256
  ds_read_b64_tr_b16 v[170:171], v11 offset:8768
  ds_read_b64_tr_b16 v[172:173], v11 offset:12352
  ds_read_b64_tr_b16 v[174:175], v11 offset:12864
  ds_read_b64_tr_b16 v[176:177], v11 offset:96
  ds_read_b64_tr_b16 v[178:179], v11 offset:608
  ds_read_b64_tr_b16 v[180:181], v11 offset:4192
  ds_read_b64_tr_b16 v[182:183], v11 offset:4704
  ds_read_b64_tr_b16 v[184:185], v11 offset:8288
  ds_read_b64_tr_b16 v[186:187], v11 offset:8800
  ds_read_b64_tr_b16 v[188:189], v11 offset:12384
  ds_read_b64_tr_b16 v[190:191], v11 offset:12896
  s_waitcnt lgkmcnt(0)
  v_mfma_f32_16x16x32_bf16 v[192:195], v[128:131], v[112:115], 0
  v_mfma_f32_16x16x32_bf16 v[192:195], v[132:135], v[116:119], v[192:195]
  v_mfma_f32_16x16x32_bf16 v[192:195], v[136:139], v[120:123], v[192:195]
  v_mfma_f32_16x16x32_bf16 v[192:195], v[140:143], v[124:127], v[192:195]
  v_mfma_f32_16x16x32_bf16 v[196:199], v[144:147], v[112:115], 0
  v_mfma_f32_16x16x32_bf16 v[196:199], v[148:151], v[116:119], v[196:199]
  v_mfma_f32_16x16x32_bf16 v[196:199], v[152:155], v[120:123], v[196:199]
  v_mfma_f32_16x16x32_bf16 v[196:199], v[156:159], v[124:127], v[196:199]
  v_mfma_f32_16x16x32_bf16 v[200:203], v[160:163], v[112:115], 0
  v_mfma_f32_16x16x32_bf16 v[200:203], v[164:167], v[116:119], v[200:203]
  v_mfma_f32_16x16x32_bf16 v[200:203], v[168:171], v[120:123], v[200:203]
  v_mfma_f32_16x16x32_bf16 v[200:203], v[172:175], v[124:127], v[200:203]
  v_mfma_f32_16x16x32_bf16 v[204:207], v[176:179], v[112:115], 0
  v_mfma_f32_16x16x32_bf16 v[204:207], v[180:183], v[116:119], v[204:207]
  v_mfma_f32_16x16x32_bf16 v[204:207], v[184:187], v[120:123], v[204:207]
  v_mfma_f32_16x16x32_bf16 v[204:207], v[188:191], v[124:127], v[204:207]
  v_mul_lo_u32 v12, v4, s89
  v_lshl_add_u32 v12, v3, 4, v12
  v_cmp_gt_u32 vcc, 4, v4
  s_and_saveexec_b64 s[42:43], vcc
  s_nop 7
  buffer_store_dwordx4 v[192:195], v12, s[24:27], s88 offen offset:0
  buffer_store_dwordx4 v[196:199], v12, s[24:27], s88 offen offset:64
  buffer_store_dwordx4 v[200:203], v12, s[24:27], s88 offen offset:128
  buffer_store_dwordx4 v[204:207], v12, s[24:27], s88 offen offset:192
  s_mov_b64 exec, s[42:43]
F_AD:
  s_mov_b32 s40, 1069066811
  s_branch F_MERGE
F_END:
  s_endpgm
.globl gated_mix__gqa_block_cached__glu_gated_glu__decode_k3_kernel
.p2align 8
.type gated_mix__gqa_block_cached__glu_gated_glu__decode_k3_kernel,@function
gated_mix__gqa_block_cached__glu_gated_glu__decode_k3_kernel:
  s_cmp_ge_u32 s2, 368
  s_cbranch_scc1 K3_END
  s_load_dwordx2 s[4:5], s[0:1], 0
  s_load_dwordx2 s[6:7], s[0:1], 32
  s_load_dwordx4 s[8:11], s[0:1], 64
  s_load_dwordx2 s[12:13], s[0:1], 80
  s_load_dwordx2 s[14:15], s[0:1], 96
  v_lshrrev_b32 v1, 6, v0
  v_and_b32 v2, 63, v0
  v_readfirstlane_b32 s44, v1
  v_lshrrev_b32 v3, 4, v2
  v_and_b32 v4, 3, v2
  s_mov_b32 s40, 1069066811
  v_lshrrev_b32 v5, 3, v2
  v_lshlrev_b32 v5, 10, v5
  v_and_b32 v6, 7, v2
  v_lshl_add_u32 v5, v6, 4, v5
  s_waitcnt lgkmcnt(0)
  s_mov_b32 s36, s14
  s_and_b32 s37, s15, 0xffff
  s_mov_b32 s38, 268435456
  s_mov_b32 s39, 0x00020000
  s_cmp_ge_u32 s2, 256
  s_cbranch_scc1 K3_DOWN
  s_mov_b32 s20, s6
  s_and_b32 s21, s7, 0xffff
  s_mov_b32 s22, 4194304
  s_mov_b32 s23, 0x00020000
  s_and_b32 s45, s2, 31
  s_lshr_b32 s46, s2, 5
  s_mov_b32 s47, s45
  s_lshl_b32 s48, s45, 17
  s_lshl_b32 s49, s46, 7
  s_add_u32 s48, s48, s49
  s_lshl_b32 s49, s44, 14
  s_add_u32 s48, s48, s49
  s_lshl_b32 s49, s44, 11
  s_add_u32 m0, s49, 0
  s_add_u32 s50, s48, 0
  buffer_load_dwordx4 v5, s[20:23], s50 offen nt lds
  s_add_u32 m0, s49, 1024
  s_add_u32 s50, s48, 8192
  buffer_load_dwordx4 v5, s[20:23], s50 offen nt lds
  v_lshrrev_b32 v7, 7, v0
  v_lshlrev_b32 v7, 18, v7
  v_and_b32 v8, 127, v0
  v_lshl_add_u32 v8, v8, 2, v7
  s_lshr_b32 s50, s45, 2
  s_lshl_b32 s50, s50, 15
  s_add_u32 s50, s50, 1048576
  s_and_b32 s51, s45, 3
  s_lshl_b32 s52, s51, 9
  s_add_u32 s52, s52, s50
  s_lshl_b32 s53, s51, 3
  s_add_u32 s53, s53, s50
  s_add_u32 s54, s52, 0
  s_add_u32 s55, s53, 0
  buffer_load_dword v32, v8, s[36:39], s54 offen
  buffer_load_dwordx2 v[16:17], v7, s[36:39], s55 offen offset:2048
  s_add_u32 s54, s52, 4096
  s_add_u32 s55, s53, 4096
  buffer_load_dword v33, v8, s[36:39], s54 offen
  buffer_load_dwordx2 v[18:19], v7, s[36:39], s55 offen offset:2048
  s_add_u32 s54, s52, 8192
  s_add_u32 s55, s53, 8192
  buffer_load_dword v34, v8, s[36:39], s54 offen
  buffer_load_dwordx2 v[20:21], v7, s[36:39], s55 offen offset:2048
  s_add_u32 s54, s52, 12288
  s_add_u32 s55, s53, 12288
  buffer_load_dword v35, v8, s[36:39], s54 offen
  buffer_load_dwordx2 v[22:23], v7, s[36:39], s55 offen offset:2048
  s_add_u32 s54, s52, 16384
  s_add_u32 s55, s53, 16384
  buffer_load_dword v36, v8, s[36:39], s54 offen
  buffer_load_dwordx2 v[24:25], v7, s[36:39], s55 offen offset:2048
  s_add_u32 s54, s52, 20480
  s_add_u32 s55, s53, 20480
  buffer_load_dword v37, v8, s[36:39], s54 offen
  buffer_load_dwordx2 v[26:27], v7, s[36:39], s55 offen offset:2048
  s_add_u32 s54, s52, 24576
  s_add_u32 s55, s53, 24576
  buffer_load_dword v38, v8, s[36:39], s54 offen
  buffer_load_dwordx2 v[28:29], v7, s[36:39], s55 offen offset:2048
  s_add_u32 s54, s52, 28672
  s_add_u32 s55, s53, 28672
  buffer_load_dword v39, v8, s[36:39], s54 offen
  buffer_load_dwordx2 v[30:31], v7, s[36:39], s55 offen offset:2048
  s_waitcnt vmcnt(0)
  v_max3_f32 v10, v16, v18, v20
  v_max3_f32 v10, v10, v22, v24
  v_max3_f32 v10, v10, v26, v28
  v_max_f32 v10, v10, v30
  v_sub_f32 v16, v16, v10
  v_mul_f32 v16, s40, v16
  v_exp_f32 v16, v16
  v_sub_f32 v18, v18, v10
  v_mul_f32 v18, s40, v18
  v_exp_f32 v18, v18
  v_sub_f32 v20, v20, v10
  v_mul_f32 v20, s40, v20
  v_exp_f32 v20, v20
  v_sub_f32 v22, v22, v10
  v_mul_f32 v22, s40, v22
  v_exp_f32 v22, v22
  v_sub_f32 v24, v24, v10
  v_mul_f32 v24, s40, v24
  v_exp_f32 v24, v24
  v_sub_f32 v26, v26, v10
  v_mul_f32 v26, s40, v26
  v_exp_f32 v26, v26
  v_sub_f32 v28, v28, v10
  v_mul_f32 v28, s40, v28
  v_exp_f32 v28, v28
  v_sub_f32 v30, v30, v10
  v_mul_f32 v30, s40, v30
  v_exp_f32 v30, v30
  s_nop 0
  v_mul_f32 v11, v16, v17
  v_mul_f32 v12, v16, v32
  v_fma_f32 v11, v18, v19, v11
  v_fma_f32 v12, v18, v33, v12
  v_fma_f32 v11, v20, v21, v11
  v_fma_f32 v12, v20, v34, v12
  v_fma_f32 v11, v22, v23, v11
  v_fma_f32 v12, v22, v35, v12
  v_fma_f32 v11, v24, v25, v11
  v_fma_f32 v12, v24, v36, v12
  v_fma_f32 v11, v26, v27, v11
  v_fma_f32 v12, v26, v37, v12
  v_fma_f32 v11, v28, v29, v11
  v_fma_f32 v12, v28, v38, v12
  v_fma_f32 v11, v30, v31, v11
  v_fma_f32 v12, v30, v39, v12
  v_rcp_f32 v11, v11
  s_nop 0
  v_mul_f32 v12, v12, v11
  s_branch K3_A
K3_DOWN:
  s_mov_b32 s20, s8
  s_and_b32 s21, s9, 0xffff
  s_mov_b32 s22, 1835008
  s_mov_b32 s23, 0x00020000
  s_sub_u32 s45, s2, 256
  s_and_b32 s46, s45, 7
  s_lshr_b32 s45, s45, 3
  s_add_u32 s47, s45, 32
  s_lshl_b32 s48, s45, 17
  s_lshl_b32 s49, s46, 7
  s_add_u32 s48, s48, s49
  s_lshl_b32 s49, s44, 14
  s_add_u32 s48, s48, s49
  s_lshl_b32 s49, s44, 11
  s_add_u32 m0, s49, 0
  s_add_u32 s50, s48, 0
  buffer_load_dwordx4 v5, s[20:23], s50 offen nt lds
  s_add_u32 m0, s49, 1024
  s_add_u32 s50, s48, 8192
  buffer_load_dwordx4 v5, s[20:23], s50 offen nt lds
  v_lshrrev_b32 v7, 7, v0
  v_mul_u32_u24 v7, 7168, v7
  v_and_b32 v8, 127, v0
  v_lshl_add_u32 v8, v8, 2, v7
  s_lshl_b32 s50, s45, 9
  s_add_u32 s54, s50, 262144
  s_add_u32 s55, s50, 393216
  buffer_load_dword v16, v8, s[36:39], s54 offen
  buffer_load_dword v20, v8, s[36:39], s55 offen
  s_add_u32 s54, s50, 290816
  s_add_u32 s55, s50, 421888
  buffer_load_dword v17, v8, s[36:39], s54 offen
  buffer_load_dword v21, v8, s[36:39], s55 offen
  s_add_u32 s54, s50, 319488
  s_add_u32 s55, s50, 450560
  buffer_load_dword v18, v8, s[36:39], s54 offen
  buffer_load_dword v22, v8, s[36:39], s55 offen
  s_add_u32 s54, s50, 348160
  s_add_u32 s55, s50, 479232
  buffer_load_dword v19, v8, s[36:39], s54 offen
  buffer_load_dword v23, v8, s[36:39], s55 offen
  s_waitcnt vmcnt(0)
  v_add_f32 v16, v16, v17
  v_add_f32 v18, v18, v19
  v_add_f32 v20, v20, v21
  v_add_f32 v22, v22, v23
  v_add_f32 v16, v16, v18
  v_add_f32 v20, v20, v22
  v_cvt_pk_bf16_f32 v16, v16, v16
  v_lshlrev_b32 v16, 16, v16
  v_cvt_pk_bf16_f32 v20, v20, v20
  v_lshlrev_b32 v20, 16, v20
  v_mul_f32 v17, 0xbfb8aa3b, v16
  v_exp_f32 v17, v17
  s_nop 0
  v_add_f32 v17, 1.0, v17
  v_rcp_f32 v16, v17
  s_nop 0
  v_cvt_pk_bf16_f32 v16, v16, v16
  v_lshlrev_b32 v16, 16, v16
  v_mul_f32 v12, v16, v20
K3_A:
  v_cvt_pk_bf16_f32 v12, v12, v12
  v_lshlrev_b32 v9, 1, v0
  ds_write_b16 v9, v12 offset:16384
  s_waitcnt lgkmcnt(0)
  s_barrier
  s_cmp_ge_u32 s44, 4
  s_cbranch_scc1 K3_FIN
  v_lshlrev_b32 v9, 8, v4
  v_lshl_add_u32 v9, v3, 4, v9
  ds_read_b128 v[64:67], v9 offset:16384
  ds_read_b128 v[68:71], v9 offset:16448
  ds_read_b128 v[72:75], v9 offset:16512
  ds_read_b128 v[76:79], v9 offset:16576
  v_and_b32 v7, 15, v2
  v_lshrrev_b32 v6, 2, v7
  v_lshl_add_u32 v6, v3, 3, v6
  v_lshlrev_b32 v6, 7, v6
  v_lshl_add_u32 v6, v4, 3, v6
  s_lshl_b32 s50, s44, 5
  v_add_u32 v6, s50, v6
  ds_read_b64_tr_b16 v[80:81], v6 offset:0
  ds_read_b64_tr_b16 v[82:83], v6 offset:512
  ds_read_b64_tr_b16 v[84:85], v6 offset:4096
  ds_read_b64_tr_b16 v[86:87], v6 offset:4608
  ds_read_b64_tr_b16 v[88:89], v6 offset:8192
  ds_read_b64_tr_b16 v[90:91], v6 offset:8704
  ds_read_b64_tr_b16 v[92:93], v6 offset:12288
  ds_read_b64_tr_b16 v[94:95], v6 offset:12800
  s_waitcnt lgkmcnt(0)
  v_mfma_f32_16x16x32_bf16 v[16:19], v[80:83], v[64:67], 0
  v_mfma_f32_16x16x32_bf16 v[16:19], v[84:87], v[68:71], v[16:19]
  v_mfma_f32_16x16x32_bf16 v[16:19], v[88:91], v[72:75], v[16:19]
  v_mfma_f32_16x16x32_bf16 v[16:19], v[92:95], v[76:79], v[16:19]
  s_mul_i32 s50, s46, 46
  s_add_u32 s50, s50, s47
  s_lshl_b32 s50, s50, 10
  s_lshl_b32 s51, s44, 6
  s_add_u32 s50, s50, s51
  s_add_u32 s50, s50, 524288
  v_lshlrev_b32 v9, 8, v7
  v_lshl_add_u32 v9, v3, 4, v9
  v_cmp_gt_u32 vcc, 4, v7
  s_and_saveexec_b64 s[56:57], vcc
  s_nop 7
  buffer_store_dwordx4 v[16:19], v9, s[36:39], s50 offen sc1
  s_endpgm
K3_FIN:
  s_cmp_lg_u32 s44, 4
  s_cbranch_scc1 K3_END
  s_cmp_ge_u32 s47, 4
  s_cbranch_scc1 K3_END
  s_mov_b32 s16, s4
  s_and_b32 s17, s5, 0xffff
  s_mov_b32 s18, 4096
  s_mov_b32 s19, 0x00020000
  s_mov_b32 s28, s10
  s_and_b32 s29, s11, 0xffff
  s_mov_b32 s30, 1024
  s_mov_b32 s31, 0x00020000
  s_mov_b32 s32, s12
  s_and_b32 s33, s13, 0xffff
  s_mov_b32 s34, 4096
  s_mov_b32 s35, 0x00020000
  v_lshlrev_b32 v10, 4, v2
  s_lshl_b32 s51, s47, 10
  buffer_load_dwordx4 v[64:67], v10, s[16:19], s51 offen
  buffer_load_dwordx4 v[68:71], v10, s[28:31], 0 offen
  s_mul_i32 s50, s46, 46*1024
  s_lshl_b32 s52, s47, 8
  s_add_u32 s50, s50, s52
  s_add_u32 s50, s50, 524288
  v_lshlrev_b32 v9, 2, v2
  s_waitcnt vmcnt(0)
  v_mov_b32 v12, 0
  v_lshlrev_b32 v13, 16, v64
  v_lshlrev_b32 v14, 16, v68
  v_mul_f32 v13, v13, v14
  v_cvt_pk_bf16_f32 v13, v13, v13
  v_lshlrev_b32 v13, 16, v13
  v_add_f32 v12, v12, v13
  v_and_b32 v13, 0xffff0000, v64
  v_and_b32 v14, 0xffff0000, v68
  v_mul_f32 v13, v13, v14
  v_cvt_pk_bf16_f32 v13, v13, v13
  v_lshlrev_b32 v13, 16, v13
  v_add_f32 v12, v12, v13
  v_lshlrev_b32 v13, 16, v65
  v_lshlrev_b32 v14, 16, v69
  v_mul_f32 v13, v13, v14
  v_cvt_pk_bf16_f32 v13, v13, v13
  v_lshlrev_b32 v13, 16, v13
  v_add_f32 v12, v12, v13
  v_and_b32 v13, 0xffff0000, v65
  v_and_b32 v14, 0xffff0000, v69
  v_mul_f32 v13, v13, v14
  v_cvt_pk_bf16_f32 v13, v13, v13
  v_lshlrev_b32 v13, 16, v13
  v_add_f32 v12, v12, v13
  v_lshlrev_b32 v13, 16, v66
  v_lshlrev_b32 v14, 16, v70
  v_mul_f32 v13, v13, v14
  v_cvt_pk_bf16_f32 v13, v13, v13
  v_lshlrev_b32 v13, 16, v13
  v_add_f32 v12, v12, v13
  v_and_b32 v13, 0xffff0000, v66
  v_and_b32 v14, 0xffff0000, v70
  v_mul_f32 v13, v13, v14
  v_cvt_pk_bf16_f32 v13, v13, v13
  v_lshlrev_b32 v13, 16, v13
  v_add_f32 v12, v12, v13
  v_lshlrev_b32 v13, 16, v67
  v_lshlrev_b32 v14, 16, v71
  v_mul_f32 v13, v13, v14
  v_cvt_pk_bf16_f32 v13, v13, v13
  v_lshlrev_b32 v13, 16, v13
  v_add_f32 v12, v12, v13
  v_and_b32 v13, 0xffff0000, v67
  v_and_b32 v14, 0xffff0000, v71
  v_mul_f32 v13, v13, v14
  v_cvt_pk_bf16_f32 v13, v13, v13
  v_lshlrev_b32 v13, 16, v13
  v_add_f32 v12, v12, v13
  s_nop 1
  v_add_f32_dpp v12, v12, v12 row_ror:8 row_mask:0xf bank_mask:0xf
  s_nop 1
  v_add_f32_dpp v12, v12, v12 row_ror:4 row_mask:0xf bank_mask:0xf
  s_nop 1
  v_add_f32_dpp v12, v12, v12 row_ror:2 row_mask:0xf bank_mask:0xf
  s_nop 1
  v_add_f32_dpp v12, v12, v12 row_ror:1 row_mask:0xf bank_mask:0xf
  v_mov_b32 v13, v12
  s_nop 1
  v_permlane32_swap_b32 v12, v13
  s_nop 1
  v_add_f32 v12, v12, v13
  v_mov_b32 v13, v12
  s_nop 1
  v_permlane16_swap_b32 v12, v13
  s_nop 1
  v_add_f32 v12, v12, v13
  v_cvt_pk_bf16_f32 v12, v12, v12
  v_lshlrev_b32 v12, 16, v12
  v_mul_f32 v13, 0xbfb8aa3b, v12
  v_exp_f32 v13, v13
  s_nop 0
  v_add_f32 v13, 1.0, v13
  v_rcp_f32 v12, v13
  s_nop 0
  v_cvt_pk_bf16_f32 v12, v12, v12
  v_lshlrev_b32 v12, 16, v12
  v_sub_f32 v13, 1.0, v12
  v_cvt_pk_bf16_f32 v13, v13, v13
  v_lshlrev_b32 v13, 16, v13
  s_mov_b32 s53, 200000
K3_LD:
  s_add_u32 s52, s50, 0
  buffer_load_dword v64, v9, s[36:39], s52 offen offset:0 sc1
  buffer_load_dword v65, v9, s[36:39], s52 offen offset:1024 sc1
  buffer_load_dword v66, v9, s[36:39], s52 offen offset:2048 sc1
  buffer_load_dword v67, v9, s[36:39], s52 offen offset:3072 sc1
  s_add_u32 s52, s50, 4096
  buffer_load_dword v68, v9, s[36:39], s52 offen offset:0 sc1
  buffer_load_dword v69, v9, s[36:39], s52 offen offset:1024 sc1
  buffer_load_dword v70, v9, s[36:39], s52 offen offset:2048 sc1
  buffer_load_dword v71, v9, s[36:39], s52 offen offset:3072 sc1
  s_add_u32 s52, s50, 8192
  buffer_load_dword v72, v9, s[36:39], s52 offen offset:0 sc1
  buffer_load_dword v73, v9, s[36:39], s52 offen offset:1024 sc1
  buffer_load_dword v74, v9, s[36:39], s52 offen offset:2048 sc1
  buffer_load_dword v75, v9, s[36:39], s52 offen offset:3072 sc1
  s_add_u32 s52, s50, 12288
  buffer_load_dword v76, v9, s[36:39], s52 offen offset:0 sc1
  buffer_load_dword v77, v9, s[36:39], s52 offen offset:1024 sc1
  buffer_load_dword v78, v9, s[36:39], s52 offen offset:2048 sc1
  buffer_load_dword v79, v9, s[36:39], s52 offen offset:3072 sc1
  s_add_u32 s52, s50, 16384
  buffer_load_dword v80, v9, s[36:39], s52 offen offset:0 sc1
  buffer_load_dword v81, v9, s[36:39], s52 offen offset:1024 sc1
  buffer_load_dword v82, v9, s[36:39], s52 offen offset:2048 sc1
  buffer_load_dword v83, v9, s[36:39], s52 offen offset:3072 sc1
  s_add_u32 s52, s50, 20480
  buffer_load_dword v84, v9, s[36:39], s52 offen offset:0 sc1
  buffer_load_dword v85, v9, s[36:39], s52 offen offset:1024 sc1
  buffer_load_dword v86, v9, s[36:39], s52 offen offset:2048 sc1
  buffer_load_dword v87, v9, s[36:39], s52 offen offset:3072 sc1
  s_add_u32 s52, s50, 24576
  buffer_load_dword v88, v9, s[36:39], s52 offen offset:0 sc1
  buffer_load_dword v89, v9, s[36:39], s52 offen offset:1024 sc1
  buffer_load_dword v90, v9, s[36:39], s52 offen offset:2048 sc1
  buffer_load_dword v91, v9, s[36:39], s52 offen offset:3072 sc1
  s_add_u32 s52, s50, 28672
  buffer_load_dword v92, v9, s[36:39], s52 offen offset:0 sc1
  buffer_load_dword v93, v9, s[36:39], s52 offen offset:1024 sc1
  buffer_load_dword v94, v9, s[36:39], s52 offen offset:2048 sc1
  buffer_load_dword v95, v9, s[36:39], s52 offen offset:3072 sc1
  s_add_u32 s52, s50, 32768
  buffer_load_dword v96, v9, s[36:39], s52 offen offset:0 sc1
  buffer_load_dword v97, v9, s[36:39], s52 offen offset:1024 sc1
  buffer_load_dword v98, v9, s[36:39], s52 offen offset:2048 sc1
  buffer_load_dword v99, v9, s[36:39], s52 offen offset:3072 sc1
  s_add_u32 s52, s50, 36864
  buffer_load_dword v100, v9, s[36:39], s52 offen offset:0 sc1
  buffer_load_dword v101, v9, s[36:39], s52 offen offset:1024 sc1
  buffer_load_dword v102, v9, s[36:39], s52 offen offset:2048 sc1
  buffer_load_dword v103, v9, s[36:39], s52 offen offset:3072 sc1
  s_add_u32 s52, s50, 40960
  buffer_load_dword v104, v9, s[36:39], s52 offen offset:0 sc1
  buffer_load_dword v105, v9, s[36:39], s52 offen offset:1024 sc1
  buffer_load_dword v106, v9, s[36:39], s52 offen offset:2048 sc1
  buffer_load_dword v107, v9, s[36:39], s52 offen offset:3072 sc1
  s_add_u32 s52, s50, 45056
  buffer_load_dword v108, v9, s[36:39], s52 offen offset:0 sc1
  buffer_load_dword v109, v9, s[36:39], s52 offen offset:1024 sc1
  s_waitcnt vmcnt(0)
  v_max3_u32 v14, v64, v65, v66
  v_max3_u32 v14, v14, v67, v68
  v_max3_u32 v14, v14, v69, v70
  v_max3_u32 v14, v14, v71, v72
  v_max3_u32 v14, v14, v73, v74
  v_max3_u32 v14, v14, v75, v76
  v_max3_u32 v14, v14, v77, v78
  v_max3_u32 v14, v14, v79, v80
  v_max3_u32 v14, v14, v81, v82
  v_max3_u32 v14, v14, v83, v84
  v_max3_u32 v14, v14, v85, v86
  v_max3_u32 v14, v14, v87, v88
  v_max3_u32 v14, v14, v89, v90
  v_max3_u32 v14, v14, v91, v92
  v_max3_u32 v14, v14, v93, v94
  v_max3_u32 v14, v14, v95, v96
  v_max3_u32 v14, v14, v97, v98
  v_max3_u32 v14, v14, v99, v100
  v_max3_u32 v14, v14, v101, v102
  v_max3_u32 v14, v14, v103, v104
  v_max3_u32 v14, v14, v105, v106
  v_max3_u32 v14, v14, v107, v108
  v_max_u32 v14, v14, v109
  v_cmp_eq_u32 vcc, -1, v14
  s_cbranch_vccz K3_LDD
  s_sub_u32 s53, s53, 1
  s_cmp_eq_u32 s53, 0
  s_cbranch_scc1 K3_LDD
  s_branch K3_LD
K3_LDD:
  v_add_f32 v64, v64, v80
  v_add_f32 v65, v65, v81
  v_add_f32 v66, v66, v82
  v_add_f32 v67, v67, v83
  v_add_f32 v68, v68, v84
  v_add_f32 v69, v69, v85
  v_add_f32 v70, v70, v86
  v_add_f32 v71, v71, v87
  v_add_f32 v72, v72, v88
  v_add_f32 v73, v73, v89
  v_add_f32 v74, v74, v90
  v_add_f32 v75, v75, v91
  v_add_f32 v76, v76, v92
  v_add_f32 v77, v77, v93
  v_add_f32 v78, v78, v94
  v_add_f32 v79, v79, v95
  v_add_f32 v64, v64, v72
  v_add_f32 v65, v65, v73
  v_add_f32 v66, v66, v74
  v_add_f32 v67, v67, v75
  v_add_f32 v68, v68, v76
  v_add_f32 v69, v69, v77
  v_add_f32 v70, v70, v78
  v_add_f32 v71, v71, v79
  v_add_f32 v64, v64, v68
  v_add_f32 v65, v65, v69
  v_add_f32 v66, v66, v70
  v_add_f32 v67, v67, v71
  v_add_f32 v64, v64, v66
  v_add_f32 v65, v65, v67
  v_add_f32 v64, v64, v65
  v_add_f32 v96, v96, v103
  v_add_f32 v97, v97, v104
  v_add_f32 v98, v98, v105
  v_add_f32 v99, v99, v106
  v_add_f32 v100, v100, v107
  v_add_f32 v101, v101, v108
  v_add_f32 v102, v102, v109
  v_add_f32 v96, v96, v97
  v_add_f32 v98, v98, v99
  v_add_f32 v100, v100, v101
  v_add_f32 v96, v96, v98
  v_add_f32 v100, v100, v102
  v_add_f32 v96, v96, v100
  v_cvt_pk_bf16_f32 v64, v64, v64
  v_lshlrev_b32 v64, 16, v64
  v_cvt_pk_bf16_f32 v96, v96, v96
  v_lshlrev_b32 v96, 16, v96
  v_mul_f32 v64, v12, v64
  v_cvt_pk_bf16_f32 v64, v64, v64
  v_lshlrev_b32 v64, 16, v64
  v_mul_f32 v96, v13, v96
  v_cvt_pk_bf16_f32 v96, v96, v96
  v_lshlrev_b32 v96, 16, v96
  v_add_f32 v64, v64, v96
  v_cvt_pk_bf16_f32 v64, v64, v64
  v_lshlrev_b32 v10, 1, v2
  s_lshl_b32 s50, s46, 7
  s_add_u32 s50, s50, s51
  buffer_store_short v64, v10, s[32:35], s50 offen
K3_END:
  s_endpgm
.section .rodata,"a"
.p2align 6
.amdhsa_kernel gated_mix__gqa_block_cached__glu_gated_glu__decode_f_kernel
  .amdhsa_next_free_vgpr 224
  .amdhsa_next_free_sgpr 96
  .amdhsa_accum_offset 224
  .amdhsa_group_segment_fixed_size 0
  .amdhsa_kernarg_size 104
  .amdhsa_user_sgpr_count 2
  .amdhsa_user_sgpr_kernarg_segment_ptr 1
  .amdhsa_system_sgpr_workgroup_id_x 1
.end_amdhsa_kernel
.p2align 6
.amdhsa_kernel gated_mix__gqa_block_cached__glu_gated_glu__decode_k3_kernel
  .amdhsa_next_free_vgpr 112
  .amdhsa_next_free_sgpr 96
  .amdhsa_accum_offset 112
  .amdhsa_group_segment_fixed_size 0
  .amdhsa_kernarg_size 104
  .amdhsa_user_sgpr_count 2
  .amdhsa_user_sgpr_kernarg_segment_ptr 1
  .amdhsa_system_sgpr_workgroup_id_x 1
.end_amdhsa_kernel
```
